```python
import torch

def _softmax(x, axis=-1):
    return torch.softmax(x, dim=axis)
def _gelu(x):
    return torch.nn.functional.gelu(x, approximate="tanh")
def _silu(x):
    return torch.nn.functional.silu(x)
def _sigmoid(x):
    return torch.sigmoid(x)
def _layernorm(x, axis=-1, eps=1e-5):
    m = x.mean(dim=axis, keepdim=True)
    v = x.var(dim=axis, keepdim=True, unbiased=False)
    return (x - m) / torch.sqrt(v + eps)
def _scatter_add(tgt, idx, src, axis=0):
    return tgt.clone().index_add_(axis, idx, src)
def _segment_sum(src, seg, n):
    out = torch.zeros((n,) + src.shape[1:], dtype=src.dtype)
    return out.index_add_(0, seg, src)
def _pad(x, pw):
    flat = tuple(v for pair in reversed(pw) for v in pair)
    return torch.nn.functional.pad(x, flat)

kernel_name = 'gated_mix__grouped_kv_mqa__compressed_kv_cla__prompt'

def setup_inputs():

    _w = (lambda a: (lambda t: t.to(torch.bfloat16) if t.is_floating_point() else t)(torch.as_tensor(a)))
    def _A_setup():
        B, S, D, H = 1, 2048, 512, 32
        Dh = D // H
        return {
            "x": _w((lambda *s: torch.randn(*s, dtype=torch.bfloat16) * 0.05)(B, S, D)),
            "wq": _w((lambda *s: torch.randn(*s, dtype=torch.bfloat16) * 1.6)(D, H * Dh)),
            "wk": _w((lambda *s: torch.randn(*s, dtype=torch.bfloat16) * 1.6)(D, Dh)),
            "wv": _w((lambda *s: torch.randn(*s, dtype=torch.bfloat16) * 0.8)(D, Dh)),
            "wo": _w((lambda *s: torch.randn(*s, dtype=torch.bfloat16) * 0.8)(H * Dh, D)),
        }
    _A_in = _A_setup()

    def _B_setup():
        B, H, Sq, Sk, D, M = 1, 32, 2048, 2048, 128, 512
        Dc = 4 * D
        return {
            "x": _w((lambda *s: torch.randn(*s, dtype=torch.bfloat16) * 0.05)(B, Sq, M)),
            "c_kv": _w((lambda *s: torch.randn(*s, dtype=torch.bfloat16) * 1.6)(B, Sk, Dc)),
            "w_q": _w((lambda *s: torch.randn(*s, dtype=torch.bfloat16) * 6.4)(M, H, D) * (M ** -0.5)),
            "w_uk": _w((lambda *s: torch.randn(*s, dtype=torch.bfloat16) * 6.4)(Dc, H, D) * (Dc ** -0.5)),
            "w_uv": _w((lambda *s: torch.randn(*s, dtype=torch.bfloat16) * 1.6)(Dc, H, D) * (Dc ** -0.5)),
            "w_o": _w((lambda *s: torch.randn(*s, dtype=torch.bfloat16) * 1.6)(H, D, M) * ((H * D) ** -0.5)),
        }
    _B_in = _B_setup()

    return {
        "A_x": _A_in["x"],
        "A_wq": _A_in["wq"],
        "A_wk": _A_in["wk"],
        "A_wv": _A_in["wv"],
        "A_wo": _A_in["wo"],
        "B_x": _B_in["x"],
        "B_c_kv": _B_in["c_kv"],
        "B_w_q": _B_in["w_q"],
        "B_w_uk": _B_in["w_uk"],
        "B_w_uv": _B_in["w_uv"],
        "B_w_o": _B_in["w_o"],
        "gate_w": _w((lambda *s: torch.randn(*s, dtype=torch.bfloat16) * 0.1)(512) * 16.0),
    }

def reference(A_x, A_wq, A_wk, A_wv, A_wo, B_x, B_c_kv, B_w_q, B_w_uk, B_w_uv, B_w_o, gate_w):
    def _A_ref(x, wq, wk, wv, wo):
        B, S, D = x.shape
        H = 32
        Dh = D // H
        q = (lambda x, *d: x.permute(*d))((x @ wq).reshape(B, S, H, Dh), 0, 2, 1, 3)
        k = x @ wk
        v = x @ wv
        scores = torch.einsum("bhqd,bkd->bhqk", q, k) * (Dh ** -0.5)
        p = _softmax(scores, axis=-1)
        o = torch.einsum("bhqk,bkd->bhqd", p, v)
        return (lambda x, *d: x.permute(*d))(o, 0, 2, 1, 3).reshape(B, S, H * Dh) @ wo

    def _B_ref(x, c_kv, w_q, w_uk, w_uv, w_o):
        B, Sq, M = x.shape[0], x.shape[1], x.shape[2]
        Sk = c_kv.shape[1]
        H, D = w_q.shape[1], w_q.shape[2]
        q = torch.einsum("bqm,mhd->bhqd", x, w_q)
        k = torch.einsum("bkc,chd->bhkd", c_kv, w_uk)
        v = torch.einsum("bkc,chd->bhkd", c_kv, w_uv)
        scores = torch.einsum("bhqd,bhkd->bhqk", q, k) * (D ** -0.5)
        off = Sk - Sq
        qi = torch.arange(Sq)[:, None]
        kj = torch.arange(Sk)[None, :]
        cmask = kj <= (qi + off)
        scores = torch.where(cmask[None, None], scores, -1e9)
        p = _softmax(scores, axis=-1)
        ctx = torch.einsum("bhqk,bhkd->bhqd", p, v)
        return torch.einsum("bhqd,hdm->bqm", ctx, w_o)

    x = A_x
    g = _sigmoid((x * gate_w).sum(-1, keepdims=True))
    a = _A_ref(x, A_wq, A_wk, A_wv, A_wo)
    b = _B_ref(x, B_c_kv, B_w_q, B_w_uk, B_w_uv, B_w_o)
    return g * a + (1 - g) * b
```

```asm
; @launch grid=(256,1,1) block=(512,1,1) lds=163840
.amdgcn_target "amdgcn-amd-amdhsa--gfx950"
.text
.globl gated_mix__grouped_kv_mqa__compressed_kv_cla__prompt_kernel
.p2align 8
.type gated_mix__grouped_kv_mqa__compressed_kv_cla__prompt_kernel,@function
gated_mix__grouped_kv_mqa__compressed_kv_cla__prompt_kernel:
    s_cmp_ge_u32 s2, 256
    s_cbranch_scc1 k1_end
    s_load_dwordx2 s[4:5], s[0:1], 48
    s_load_dwordx4 s[24:27], s[0:1], 64
    s_load_dwordx4 s[8:11], s[0:1], 104
    s_load_dwordx2 s[64:65], s[0:1], 0
    s_load_dwordx4 s[68:71], s[0:1], 16
    s_load_dwordx2 s[72:73], s[0:1], 88
    s_load_dwordx2 s[54:55], s[0:1], 56
    s_load_dwordx2 s[56:57], s[0:1], 80
    s_load_dwordx2 s[58:59], s[0:1], 8
    s_load_dwordx2 s[60:61], s[0:1], 32
    s_load_dwordx2 s[74:75], s[0:1], 96
    v_lshrrev_b32 v2, 6, v0
    v_and_b32 v0, 63, v0
    v_lshlrev_b32 v1, 4, v0
    v_readfirstlane_b32 s3, v2
    s_and_b32 s6, s2, 31
    s_lshr_b32 s7, s2, 5
    s_waitcnt lgkmcnt(0)
    s_mov_b32 s30, s10
    s_mov_b32 s31, s11
    s_mov_b32 s20, s30
    s_mov_b32 s21, s31
    s_mov_b32 s22, 134217728
    s_mov_b32 s23, 0x00020000
    s_mov_b32 s80, s8
    s_mov_b32 s81, s9
    s_mov_b32 s82, 256
    s_mov_b32 s83, 0x00020000
    s_mov_b32 s76, s64
    s_mov_b32 s77, s65
    s_mov_b32 s78, 2097152
    s_mov_b32 s79, 0x00020000
    s_mov_b32 s88, s72
    s_mov_b32 s89, s73
    s_mov_b32 s90, 1024
    s_mov_b32 s91, 0x00020000
    s_lshl_b32 s28, s6, 19
    s_add_u32 s84, s30, s28
    s_addc_u32 s85, s31, 0
    s_mov_b32 s86, 524288
    s_mov_b32 s87, 0x00020000
    s_add_u32 s32, s84, 16760832
    s_addc_u32 s33, s85, 0
    s_mov_b32 s34, 540672
    s_mov_b32 s35, 0x00020000
    s_mov_b32 s36, s4
    s_mov_b32 s37, s5
    s_mov_b32 s38, 2097152
    s_mov_b32 s39, 0x00020000
    s_mov_b32 s12, s24
    s_mov_b32 s13, s25
    s_mov_b32 s14, 4194304
    s_mov_b32 s15, 0x00020000
    v_mov_b32 v30, 0
    v_mov_b32 v31, 0
    v_lshrrev_b32 v3, 3, v0
    v_lshrrev_b32 v4, 4, v0
    v_and_b32 v5, 7, v0
    v_xor_b32 v6, v5, v4
    v_xor_b32 v7, 4, v6
    v_lshlrev_b32 v3, 10, v3
    v_lshl_add_u32 v6, v6, 4, v3
    v_lshl_add_u32 v7, v7, 4, v3
    s_lshl_b32 s28, s7, 8
    s_lshl_b32 s29, s3, 5
    s_add_u32 s28, s28, s29
    s_lshl_b32 s28, s28, 10
    v_add_u32 v8, s28, v6
    v_add_u32 v9, s28, v7
    s_sub_u32 s28, 15, s7
    s_cmp_lt_u32 s3, 4
    s_cselect_b32 s28, s28, s7
    s_lshl_b32 s28, s28, 7
    s_and_b32 s29, s3, 3
    s_lshl_b32 s29, s29, 5
    s_add_u32 s28, s28, s29
    s_lshl_b32 s44, s28, 10
    v_add_u32 v11, s44, v6
    s_sub_u32 s44, s44, 0
    v_add_u32 v2, s44, v7
    v_and_b32 v5, 15, v0
    v_lshlrev_b32 v6, 2, v4
    v_xor_b32 v5, v5, v6
    s_lshl_b32 s28, s3, 3
    v_add_u32 v6, s28, v4
    v_lshlrev_b32 v6, 13, v6
    v_lshl_add_u32 v6, v5, 4, v6
    s_lshl_b32 s28, s6, 8
    v_add_u32 v10, s28, v6
    v_mov_b32 v112, v11
    v_mov_b32 v113, v2
    s_lshl_b32 s45, s3, 12
    s_lshl_b32 s46, s3, 11
    s_add_u32 s46, s46, 32768
    s_mov_b32 s42, 0
    s_mov_b32 s43, 0
    s_add_u32 m0, s45, 0
    s_add_u32 s40, s42, 0
    buffer_load_dwordx4 v8, s[36:39], s40 offen offset:0 lds
    s_add_u32 s40, s42, 7168
    buffer_load_dwordx4 v9, s[36:39], s40 offen offset:1024 lds
    s_add_u32 s40, s42, 14336
    buffer_load_dwordx4 v8, s[36:39], s40 offen offset:2048 lds
    s_add_u32 s40, s42, 21504
    buffer_load_dwordx4 v9, s[36:39], s40 offen offset:3072 lds
    s_add_u32 m0, s46, 0
    s_add_u32 s40, s43, 31744
    buffer_load_dwordx4 v10, s[12:15], s43 offen lds
    buffer_load_dwordx4 v10, s[12:15], s40 offen offset:1024 lds
    s_add_u32 s42, s42, 128
    s_and_b32 s42, s42, 1023
    s_lshl_b32 s43, s42, 12
    s_add_u32 m0, s45, 49152
    s_add_u32 s40, s42, 0
    buffer_load_dwordx4 v8, s[36:39], s40 offen offset:0 lds
    s_add_u32 s40, s42, 7168
    buffer_load_dwordx4 v9, s[36:39], s40 offen offset:1024 lds
    s_add_u32 s40, s42, 14336
    buffer_load_dwordx4 v8, s[36:39], s40 offen offset:2048 lds
    s_add_u32 s40, s42, 21504
    buffer_load_dwordx4 v9, s[36:39], s40 offen offset:3072 lds
    s_add_u32 m0, s46, 49152
    s_add_u32 s40, s43, 31744
    buffer_load_dwordx4 v10, s[12:15], s43 offen lds
    buffer_load_dwordx4 v10, s[12:15], s40 offen offset:1024 lds
    s_add_u32 s42, s42, 128
    s_and_b32 s42, s42, 1023
    s_lshl_b32 s43, s42, 12
    s_add_u32 m0, s45, 98304
    s_add_u32 s40, s42, 0
    buffer_load_dwordx4 v8, s[36:39], s40 offen offset:0 lds
    s_add_u32 s40, s42, 7168
    buffer_load_dwordx4 v9, s[36:39], s40 offen offset:1024 lds
    s_add_u32 s40, s42, 14336
    buffer_load_dwordx4 v8, s[36:39], s40 offen offset:2048 lds
    s_add_u32 s40, s42, 21504
    buffer_load_dwordx4 v9, s[36:39], s40 offen offset:3072 lds
    s_add_u32 m0, s46, 98304
    s_add_u32 s40, s43, 31744
    buffer_load_dwordx4 v10, s[12:15], s43 offen lds
    buffer_load_dwordx4 v10, s[12:15], s40 offen offset:1024 lds
    s_add_u32 s42, s42, 128
    s_and_b32 s42, s42, 1023
    s_lshl_b32 s43, s42, 12
    v_and_b32 v3, 31, v0
    s_lshr_b32 s28, s3, 1
    s_lshl_b32 s28, s28, 6
    v_add_u32 v3, s28, v3
    v_lshlrev_b32 v3, 7, v3
    v_lshrrev_b32 v5, 5, v0
    v_bfe_u32 v6, v0, 1, 3
    v_xor_b32 v5, v5, v6
    v_lshl_add_u32 v12, v5, 4, v3
    v_xor_b32 v13, 32, v12
    v_xor_b32 v14, 64, v12
    v_xor_b32 v15, 96, v12
    v_add_u32 v16, 49152, v12
    v_add_u32 v17, 49152, v13
    v_add_u32 v18, 49152, v14
    v_add_u32 v19, 49152, v15
    v_add_u32 v20, 98304, v12
    v_add_u32 v21, 98304, v13
    v_add_u32 v22, 98304, v14
    v_add_u32 v23, 98304, v15
    v_lshrrev_b32 v3, 5, v0
    v_bfe_u32 v5, v0, 2, 2
    v_lshl_add_u32 v3, v3, 3, v5
    v_lshlrev_b32 v3, 8, v3
    v_bfe_u32 v6, v0, 4, 1
    v_lshl_add_u32 v3, v6, 5, v3
    v_and_b32 v6, 3, v0
    v_lshl_add_u32 v3, v6, 3, v3
    v_lshl_add_u32 v3, v5, 6, v3
    s_and_b32 s28, s3, 1
    s_lshl_b32 s28, s28, 7
    v_xor_b32 v3, s28, v3
    v_add_u32 v24, 32768, v3
    v_xor_b32 v25, 64, v24
    v_add_u32 v26, 49152, v24
    v_add_u32 v27, 49152, v25
    v_add_u32 v28, 98304, v24
    v_add_u32 v29, 98304, v25
    s_lshl_b32 s28, s6, 19
    s_lshl_b32 s29, s7, 16
    s_add_u32 s28, s28, s29
    s_lshr_b32 s29, s3, 1
    s_lshl_b32 s29, s29, 14
    s_add_u32 s28, s28, s29
    s_and_b32 s29, s3, 1
    s_lshl_b32 s48, s29, 12
    s_add_u32 s48, s48, s28
    s_add_u32 s48, s48, 0
    s_add_u32 s49, s48, 8192
    s_lshl_b32 s50, s29, 11
    s_add_u32 s50, s50, s28
    s_add_u32 s50, s50, 16777216
    s_add_u32 s51, s50, 4096
    s_add_u32 s52, s50, 8192
    s_add_u32 s53, s50, 12288
    s_waitcnt vmcnt(12)
    s_barrier
    s_cmp_lg_u32 s7, 0
    s_cbranch_scc1 k1_noinit
    s_cmp_lg_u32 s3, 6
    s_cbranch_scc1 k1_noinit
    v_lshlrev_b32 v2, 2, v0
    v_mov_b32 v3, 0
    s_lshl_b32 s28, s6, 8
    s_add_u32 s28, s28, 57688064
    buffer_store_dword v3, v2, s[20:23], s28 offen sc1
    s_cmp_lg_u32 s2, 0
    s_cbranch_scc1 k1_init2
    v_lshlrev_b32 v2, 8, v0
    s_mov_b32 s28, 57671680
    buffer_store_dword v3, v2, s[20:23], s28 offen sc1
k1_init2:
    s_waitcnt vmcnt(0)
    v_mov_b32 v2, 1
    s_mov_b64 exec, 1
    buffer_store_byte v2, v3, s[80:83], s6 offen sc1
    s_mov_b64 exec, -1
    s_waitcnt vmcnt(0)
k1_noinit:
    ds_read_b128 v[64:67], v12
    ds_read_b128 v[68:71], v12 offset:4096
    ds_read_b64_tr_b16 v[72:73], v24 offset:0
    ds_read_b64_tr_b16 v[74:75], v24 offset:1024
    ds_read_b64_tr_b16 v[76:77], v25 offset:0
    ds_read_b64_tr_b16 v[78:79], v25 offset:1024
    ds_read_b128 v[80:83], v13
    ds_read_b128 v[84:87], v13 offset:4096
    ds_read_b64_tr_b16 v[88:89], v24 offset:4096
    ds_read_b64_tr_b16 v[90:91], v24 offset:5120
    ds_read_b64_tr_b16 v[92:93], v25 offset:4096
    ds_read_b64_tr_b16 v[94:95], v25 offset:5120
    s_waitcnt lgkmcnt(6)
    v_mfma_f32_32x32x16_bf16 v[128:143], v[72:75], v[64:67], 0
    ds_read_b128 v[96:99], v14
    ds_read_b128 v[100:103], v14 offset:4096
    s_lshr_b32 s28, s2, 3
    s_lshl_b32 s28, s28, 3
    s_add_u32 s28, s28, s3
    s_lshl_b32 s28, s28, 13
    v_lshlrev_b32 v2, 7, v0
    buffer_load_dword v114, v2, s[36:39], s28 offen
    v_mfma_f32_32x32x16_bf16 v[144:159], v[72:75], v[68:71], 0
    ds_read_b64_tr_b16 v[104:105], v24 offset:8192
    ds_read_b64_tr_b16 v[106:107], v24 offset:9216
    v_bfe_u32 v3, v0, 1, 3
    v_lshlrev_b32 v3, 13, v3
    v_and_b32 v4, 1, v0
    v_lshl_add_u32 v3, v4, 7, v3
    s_lshl_b32 s29, s7, 19
    v_mfma_f32_32x32x16_bf16 v[160:175], v[76:79], v[64:67], 0
    ds_read_b64_tr_b16 v[108:109], v25 offset:8192
    ds_read_b64_tr_b16 v[110:111], v25 offset:9216
    s_lshl_b32 s41, s3, 16
    s_add_u32 s29, s29, s41
    s_lshl_b32 s41, s6, 8
    s_add_u32 s29, s29, s41
    buffer_load_dword v115, v3, s[12:15], s29 offen
    v_mfma_f32_32x32x16_bf16 v[176:191], v[76:79], v[68:71], 0
    s_mov_b32 s92, s26
    s_mov_b32 s93, s27
    s_mov_b32 s94, 4194304
    s_mov_b32 s95, 0x00020000
    buffer_load_dword v116, v3, s[92:95], s29 offen
    s_waitcnt lgkmcnt(6)
    v_mfma_f32_32x32x16_bf16 v[128:143], v[88:91], v[80:83], v[128:143]
    ds_read_b128 v[64:67], v15
    ds_read_b128 v[68:71], v15 offset:4096
    v_mfma_f32_32x32x16_bf16 v[144:159], v[88:91], v[84:87], v[144:159]
    ds_read_b64_tr_b16 v[72:73], v24 offset:12288
    ds_read_b64_tr_b16 v[74:75], v24 offset:13312
    v_mfma_f32_32x32x16_bf16 v[160:175], v[92:95], v[80:83], v[160:175]
    ds_read_b64_tr_b16 v[76:77], v25 offset:12288
    ds_read_b64_tr_b16 v[78:79], v25 offset:13312
    v_mfma_f32_32x32x16_bf16 v[176:191], v[92:95], v[84:87], v[176:191]
    s_waitcnt vmcnt(9) lgkmcnt(0)
    s_barrier
    v_mfma_f32_32x32x16_bf16 v[128:143], v[104:107], v[96:99], v[128:143]
    ds_read_b128 v[80:83], v16
    ds_read_b128 v[84:87], v16 offset:4096
    s_add_u32 m0, s45, 0
    s_add_u32 s40, s42, 0
    v_mfma_f32_32x32x16_bf16 v[144:159], v[104:107], v[100:103], v[144:159]
    ds_read_b64_tr_b16 v[88:89], v26 offset:0
    ds_read_b64_tr_b16 v[90:91], v26 offset:1024
    buffer_load_dwordx4 v8, s[36:39], s40 offen offset:0 lds
    s_add_u32 s40, s42, 7168
    v_mfma_f32_32x32x16_bf16 v[160:175], v[108:111], v[96:99], v[160:175]
    ds_read_b64_tr_b16 v[92:93], v27 offset:0
    ds_read_b64_tr_b16 v[94:95], v27 offset:1024
    buffer_load_dwordx4 v9, s[36:39], s40 offen offset:1024 lds
    s_add_u32 s40, s42, 14336
    v_mfma_f32_32x32x16_bf16 v[176:191], v[108:111], v[100:103], v[176:191]
    buffer_load_dwordx4 v8, s[36:39], s40 offen offset:2048 lds
    s_add_u32 s40, s42, 21504
    s_waitcnt lgkmcnt(6)
    v_mfma_f32_32x32x16_bf16 v[128:143], v[72:75], v[64:67], v[128:143]
    ds_read_b128 v[96:99], v17
    ds_read_b128 v[100:103], v17 offset:4096
    buffer_load_dwordx4 v9, s[36:39], s40 offen offset:3072 lds
    s_add_u32 m0, s46, 0
    v_mfma_f32_32x32x16_bf16 v[144:159], v[72:75], v[68:71], v[144:159]
    ds_read_b64_tr_b16 v[104:105], v26 offset:4096
    ds_read_b64_tr_b16 v[106:107], v26 offset:5120
    s_add_u32 s40, s43, 31744
    buffer_load_dwordx4 v10, s[12:15], s43 offen lds
    v_mfma_f32_32x32x16_bf16 v[160:175], v[76:79], v[64:67], v[160:175]
    ds_read_b64_tr_b16 v[108:109], v27 offset:4096
    ds_read_b64_tr_b16 v[110:111], v27 offset:5120
    buffer_load_dwordx4 v10, s[12:15], s40 offen offset:1024 lds
    s_add_u32 s42, s42, 128
    v_mfma_f32_32x32x16_bf16 v[176:191], v[76:79], v[68:71], v[176:191]
    s_and_b32 s42, s42, 1023
    s_lshl_b32 s43, s42, 12
    s_waitcnt lgkmcnt(6)
    v_mfma_f32_32x32x16_bf16 v[128:143], v[88:91], v[80:83], v[128:143]
    ds_read_b128 v[64:67], v18
    ds_read_b128 v[68:71], v18 offset:4096
    v_mfma_f32_32x32x16_bf16 v[144:159], v[88:91], v[84:87], v[144:159]
    ds_read_b64_tr_b16 v[72:73], v26 offset:8192
    ds_read_b64_tr_b16 v[74:75], v26 offset:9216
    v_mfma_f32_32x32x16_bf16 v[160:175], v[92:95], v[80:83], v[160:175]
    ds_read_b64_tr_b16 v[76:77], v27 offset:8192
    ds_read_b64_tr_b16 v[78:79], v27 offset:9216
    v_mfma_f32_32x32x16_bf16 v[176:191], v[92:95], v[84:87], v[176:191]
    s_waitcnt lgkmcnt(6)
    v_mfma_f32_32x32x16_bf16 v[128:143], v[104:107], v[96:99], v[128:143]
    ds_read_b128 v[80:83], v19
    ds_read_b128 v[84:87], v19 offset:4096
    v_mfma_f32_32x32x16_bf16 v[144:159], v[104:107], v[100:103], v[144:159]
    ds_read_b64_tr_b16 v[88:89], v26 offset:12288
    ds_read_b64_tr_b16 v[90:91], v26 offset:13312
    v_mfma_f32_32x32x16_bf16 v[160:175], v[108:111], v[96:99], v[160:175]
    ds_read_b64_tr_b16 v[92:93], v27 offset:12288
    ds_read_b64_tr_b16 v[94:95], v27 offset:13312
    v_mfma_f32_32x32x16_bf16 v[176:191], v[108:111], v[100:103], v[176:191]
    s_waitcnt vmcnt(9) lgkmcnt(0)
    s_barrier
    v_mfma_f32_32x32x16_bf16 v[128:143], v[72:75], v[64:67], v[128:143]
    ds_read_b128 v[96:99], v20
    ds_read_b128 v[100:103], v20 offset:4096
    s_add_u32 m0, s45, 49152
    s_add_u32 s40, s42, 0
    v_mfma_f32_32x32x16_bf16 v[144:159], v[72:75], v[68:71], v[144:159]
    ds_read_b64_tr_b16 v[104:105], v28 offset:0
    ds_read_b64_tr_b16 v[106:107], v28 offset:1024
    buffer_load_dwordx4 v8, s[36:39], s40 offen offset:0 lds
    s_add_u32 s40, s42, 7168
    v_mfma_f32_32x32x16_bf16 v[160:175], v[76:79], v[64:67], v[160:175]
    ds_read_b64_tr_b16 v[108:109], v29 offset:0
    ds_read_b64_tr_b16 v[110:111], v29 offset:1024
    buffer_load_dwordx4 v9, s[36:39], s40 offen offset:1024 lds
    s_add_u32 s40, s42, 14336
    v_mfma_f32_32x32x16_bf16 v[176:191], v[76:79], v[68:71], v[176:191]
    buffer_load_dwordx4 v8, s[36:39], s40 offen offset:2048 lds
    s_add_u32 s40, s42, 21504
    s_waitcnt lgkmcnt(6)
    v_mfma_f32_32x32x16_bf16 v[128:143], v[88:91], v[80:83], v[128:143]
    ds_read_b128 v[64:67], v21
    ds_read_b128 v[68:71], v21 offset:4096
    buffer_load_dwordx4 v9, s[36:39], s40 offen offset:3072 lds
    s_add_u32 m0, s46, 49152
    v_mfma_f32_32x32x16_bf16 v[144:159], v[88:91], v[84:87], v[144:159]
    ds_read_b64_tr_b16 v[72:73], v28 offset:4096
    ds_read_b64_tr_b16 v[74:75], v28 offset:5120
    s_add_u32 s40, s43, 31744
    buffer_load_dwordx4 v10, s[12:15], s43 offen lds
    v_mfma_f32_32x32x16_bf16 v[160:175], v[92:95], v[80:83], v[160:175]
    ds_read_b64_tr_b16 v[76:77], v29 offset:4096
    ds_read_b64_tr_b16 v[78:79], v29 offset:5120
    buffer_load_dwordx4 v10, s[12:15], s40 offen offset:1024 lds
    s_add_u32 s42, s42, 128
    v_mfma_f32_32x32x16_bf16 v[176:191], v[92:95], v[84:87], v[176:191]
    s_and_b32 s42, s42, 1023
    s_lshl_b32 s43, s42, 12
    s_waitcnt lgkmcnt(6)
    v_mfma_f32_32x32x16_bf16 v[128:143], v[104:107], v[96:99], v[128:143]
    ds_read_b128 v[80:83], v22
    ds_read_b128 v[84:87], v22 offset:4096
    v_mfma_f32_32x32x16_bf16 v[144:159], v[104:107], v[100:103], v[144:159]
    ds_read_b64_tr_b16 v[88:89], v28 offset:8192
    ds_read_b64_tr_b16 v[90:91], v28 offset:9216
    v_mfma_f32_32x32x16_bf16 v[160:175], v[108:111], v[96:99], v[160:175]
    ds_read_b64_tr_b16 v[92:93], v29 offset:8192
    ds_read_b64_tr_b16 v[94:95], v29 offset:9216
    v_mfma_f32_32x32x16_bf16 v[176:191], v[108:111], v[100:103], v[176:191]
    s_waitcnt lgkmcnt(6)
    v_mfma_f32_32x32x16_bf16 v[128:143], v[72:75], v[64:67], v[128:143]
    ds_read_b128 v[96:99], v23
    ds_read_b128 v[100:103], v23 offset:4096
    v_mfma_f32_32x32x16_bf16 v[144:159], v[72:75], v[68:71], v[144:159]
    ds_read_b64_tr_b16 v[104:105], v28 offset:12288
    ds_read_b64_tr_b16 v[106:107], v28 offset:13312
    v_mfma_f32_32x32x16_bf16 v[160:175], v[76:79], v[64:67], v[160:175]
    ds_read_b64_tr_b16 v[108:109], v29 offset:12288
    ds_read_b64_tr_b16 v[110:111], v29 offset:13312
    v_mfma_f32_32x32x16_bf16 v[176:191], v[76:79], v[68:71], v[176:191]
    s_waitcnt vmcnt(6) lgkmcnt(0)
    s_barrier
    v_mfma_f32_32x32x16_bf16 v[128:143], v[88:91], v[80:83], v[128:143]
    ds_read_b128 v[64:67], v12
    ds_read_b128 v[68:71], v12 offset:4096
    s_add_u32 m0, s45, 98304
    s_add_u32 s40, s42, 0
    v_mfma_f32_32x32x16_bf16 v[144:159], v[88:91], v[84:87], v[144:159]
    ds_read_b64_tr_b16 v[72:73], v24 offset:0
    ds_read_b64_tr_b16 v[74:75], v24 offset:1024
    buffer_load_dwordx4 v8, s[36:39], s40 offen offset:0 lds
    s_add_u32 s40, s42, 7168
    v_mfma_f32_32x32x16_bf16 v[160:175], v[92:95], v[80:83], v[160:175]
    ds_read_b64_tr_b16 v[76:77], v25 offset:0
    ds_read_b64_tr_b16 v[78:79], v25 offset:1024
    buffer_load_dwordx4 v9, s[36:39], s40 offen offset:1024 lds
    s_add_u32 s40, s42, 14336
    v_mfma_f32_32x32x16_bf16 v[176:191], v[92:95], v[84:87], v[176:191]
    buffer_load_dwordx4 v8, s[36:39], s40 offen offset:2048 lds
    s_add_u32 s40, s42, 21504
    s_waitcnt lgkmcnt(6)
    v_mfma_f32_32x32x16_bf16 v[128:143], v[104:107], v[96:99], v[128:143]
    ds_read_b128 v[80:83], v13
    ds_read_b128 v[84:87], v13 offset:4096
    buffer_load_dwordx4 v9, s[36:39], s40 offen offset:3072 lds
    s_add_u32 m0, s46, 98304
    v_mfma_f32_32x32x16_bf16 v[144:159], v[104:107], v[100:103], v[144:159]
    ds_read_b64_tr_b16 v[88:89], v24 offset:4096
    ds_read_b64_tr_b16 v[90:91], v24 offset:5120
    s_add_u32 s40, s43, 31744
    buffer_load_dwordx4 v10, s[12:15], s43 offen lds
    v_mfma_f32_32x32x16_bf16 v[160:175], v[108:111], v[96:99], v[160:175]
    ds_read_b64_tr_b16 v[92:93], v25 offset:4096
    ds_read_b64_tr_b16 v[94:95], v25 offset:5120
    buffer_load_dwordx4 v10, s[12:15], s40 offen offset:1024 lds
    s_add_u32 s42, s42, 128
    v_mfma_f32_32x32x16_bf16 v[176:191], v[108:111], v[100:103], v[176:191]
    s_and_b32 s42, s42, 1023
    s_lshl_b32 s43, s42, 12
    s_waitcnt lgkmcnt(6)
    v_mfma_f32_32x32x16_bf16 v[128:143], v[72:75], v[64:67], v[128:143]
    ds_read_b128 v[96:99], v14
    ds_read_b128 v[100:103], v14 offset:4096
    v_mfma_f32_32x32x16_bf16 v[144:159], v[72:75], v[68:71], v[144:159]
    ds_read_b64_tr_b16 v[104:105], v24 offset:8192
    ds_read_b64_tr_b16 v[106:107], v24 offset:9216
    v_mfma_f32_32x32x16_bf16 v[160:175], v[76:79], v[64:67], v[160:175]
    ds_read_b64_tr_b16 v[108:109], v25 offset:8192
    ds_read_b64_tr_b16 v[110:111], v25 offset:9216
    v_mfma_f32_32x32x16_bf16 v[176:191], v[76:79], v[68:71], v[176:191]
    s_waitcnt lgkmcnt(6)
    v_mfma_f32_32x32x16_bf16 v[128:143], v[88:91], v[80:83], v[128:143]
    ds_read_b128 v[64:67], v15
    ds_read_b128 v[68:71], v15 offset:4096
    v_mfma_f32_32x32x16_bf16 v[144:159], v[88:91], v[84:87], v[144:159]
    ds_read_b64_tr_b16 v[72:73], v24 offset:12288
    ds_read_b64_tr_b16 v[74:75], v24 offset:13312
    v_mfma_f32_32x32x16_bf16 v[160:175], v[92:95], v[80:83], v[160:175]
    ds_read_b64_tr_b16 v[76:77], v25 offset:12288
    ds_read_b64_tr_b16 v[78:79], v25 offset:13312
    v_mfma_f32_32x32x16_bf16 v[176:191], v[92:95], v[84:87], v[176:191]
    s_waitcnt vmcnt(6) lgkmcnt(0)
    s_barrier
    v_mfma_f32_32x32x16_bf16 v[128:143], v[104:107], v[96:99], v[128:143]
    ds_read_b128 v[80:83], v16
    ds_read_b128 v[84:87], v16 offset:4096
    s_add_u32 m0, s45, 0
    s_add_u32 s40, s42, 0
    v_mfma_f32_32x32x16_bf16 v[144:159], v[104:107], v[100:103], v[144:159]
    ds_read_b64_tr_b16 v[88:89], v26 offset:0
    ds_read_b64_tr_b16 v[90:91], v26 offset:1024
    buffer_load_dwordx4 v8, s[36:39], s40 offen offset:0 lds
    s_add_u32 s40, s42, 7168
    v_mfma_f32_32x32x16_bf16 v[160:175], v[108:111], v[96:99], v[160:175]
    ds_read_b64_tr_b16 v[92:93], v27 offset:0
    ds_read_b64_tr_b16 v[94:95], v27 offset:1024
    buffer_load_dwordx4 v9, s[36:39], s40 offen offset:1024 lds
    s_add_u32 s40, s42, 14336
    v_mfma_f32_32x32x16_bf16 v[176:191], v[108:111], v[100:103], v[176:191]
    buffer_load_dwordx4 v8, s[36:39], s40 offen offset:2048 lds
    s_add_u32 s40, s42, 21504
    s_waitcnt lgkmcnt(6)
    v_mfma_f32_32x32x16_bf16 v[128:143], v[72:75], v[64:67], v[128:143]
    ds_read_b128 v[96:99], v17
    ds_read_b128 v[100:103], v17 offset:4096
    buffer_load_dwordx4 v9, s[36:39], s40 offen offset:3072 lds
    s_add_u32 m0, s46, 0
    v_mfma_f32_32x32x16_bf16 v[144:159], v[72:75], v[68:71], v[144:159]
    ds_read_b64_tr_b16 v[104:105], v26 offset:4096
    ds_read_b64_tr_b16 v[106:107], v26 offset:5120
    s_add_u32 s40, s43, 31744
    buffer_load_dwordx4 v10, s[12:15], s43 offen lds
    v_mfma_f32_32x32x16_bf16 v[160:175], v[76:79], v[64:67], v[160:175]
    ds_read_b64_tr_b16 v[108:109], v27 offset:4096
    ds_read_b64_tr_b16 v[110:111], v27 offset:5120
    buffer_load_dwordx4 v10, s[12:15], s40 offen offset:1024 lds
    s_add_u32 s42, s42, 128
    v_mfma_f32_32x32x16_bf16 v[176:191], v[76:79], v[68:71], v[176:191]
    s_and_b32 s42, s42, 1023
    s_lshl_b32 s43, s42, 12
    s_waitcnt lgkmcnt(6)
    v_mfma_f32_32x32x16_bf16 v[128:143], v[88:91], v[80:83], v[128:143]
    ds_read_b128 v[64:67], v18
    ds_read_b128 v[68:71], v18 offset:4096
    s_lshr_b32 s28, s2, 3
    s_lshl_b32 s28, s28, 3
    v_mfma_f32_32x32x16_bf16 v[144:159], v[88:91], v[84:87], v[144:159]
    ds_read_b64_tr_b16 v[72:73], v26 offset:8192
    ds_read_b64_tr_b16 v[74:75], v26 offset:9216
    s_add_u32 s28, s28, s3
    s_lshl_b32 s28, s28, 13
    v_mfma_f32_32x32x16_bf16 v[160:175], v[92:95], v[80:83], v[160:175]
    ds_read_b64_tr_b16 v[76:77], v27 offset:8192
    ds_read_b64_tr_b16 v[78:79], v27 offset:9216
    buffer_load_dword v114, v2, s[76:79], s28 offen
    s_mov_b32 s92, s54
    v_mfma_f32_32x32x16_bf16 v[176:191], v[92:95], v[84:87], v[176:191]
    s_mov_b32 s93, s55
    buffer_load_dword v115, v3, s[92:95], s29 offen
    s_waitcnt lgkmcnt(6)
    v_mfma_f32_32x32x16_bf16 v[128:143], v[104:107], v[96:99], v[128:143]
    ds_read_b128 v[80:83], v19
    ds_read_b128 v[84:87], v19 offset:4096
    v_mfma_f32_32x32x16_bf16 v[144:159], v[104:107], v[100:103], v[144:159]
    ds_read_b64_tr_b16 v[88:89], v26 offset:12288
    ds_read_b64_tr_b16 v[90:91], v26 offset:13312
    v_mfma_f32_32x32x16_bf16 v[160:175], v[108:111], v[96:99], v[160:175]
    ds_read_b64_tr_b16 v[92:93], v27 offset:12288
    ds_read_b64_tr_b16 v[94:95], v27 offset:13312
    v_mfma_f32_32x32x16_bf16 v[176:191], v[108:111], v[100:103], v[176:191]
    s_waitcnt vmcnt(8) lgkmcnt(0)
    s_barrier
    v_mfma_f32_32x32x16_bf16 v[128:143], v[72:75], v[64:67], v[128:143]
    ds_read_b128 v[96:99], v20
    ds_read_b128 v[100:103], v20 offset:4096
    s_add_u32 m0, s45, 49152
    s_add_u32 s40, s42, 0
    v_mfma_f32_32x32x16_bf16 v[144:159], v[72:75], v[68:71], v[144:159]
    ds_read_b64_tr_b16 v[104:105], v28 offset:0
    ds_read_b64_tr_b16 v[106:107], v28 offset:1024
    buffer_load_dwordx4 v8, s[36:39], s40 offen offset:0 lds
    s_add_u32 s40, s42, 7168
    v_mfma_f32_32x32x16_bf16 v[160:175], v[76:79], v[64:67], v[160:175]
    ds_read_b64_tr_b16 v[108:109], v29 offset:0
    ds_read_b64_tr_b16 v[110:111], v29 offset:1024
    buffer_load_dwordx4 v9, s[36:39], s40 offen offset:1024 lds
    s_add_u32 s40, s42, 14336
    v_mfma_f32_32x32x16_bf16 v[176:191], v[76:79], v[68:71], v[176:191]
    buffer_load_dwordx4 v8, s[36:39], s40 offen offset:2048 lds
    s_add_u32 s40, s42, 21504
    s_waitcnt lgkmcnt(6)
    v_mfma_f32_32x32x16_bf16 v[128:143], v[88:91], v[80:83], v[128:143]
    ds_read_b128 v[64:67], v21
    ds_read_b128 v[68:71], v21 offset:4096
    buffer_load_dwordx4 v9, s[36:39], s40 offen offset:3072 lds
    s_add_u32 m0, s46, 49152
    v_mfma_f32_32x32x16_bf16 v[144:159], v[88:91], v[84:87], v[144:159]
    ds_read_b64_tr_b16 v[72:73], v28 offset:4096
    ds_read_b64_tr_b16 v[74:75], v28 offset:5120
    s_add_u32 s40, s43, 31744
    buffer_load_dwordx4 v10, s[12:15], s43 offen lds
    v_mfma_f32_32x32x16_bf16 v[160:175], v[92:95], v[80:83], v[160:175]
    ds_read_b64_tr_b16 v[76:77], v29 offset:4096
    ds_read_b64_tr_b16 v[78:79], v29 offset:5120
    buffer_load_dwordx4 v10, s[12:15], s40 offen offset:1024 lds
    s_add_u32 s42, s42, 128
    v_mfma_f32_32x32x16_bf16 v[176:191], v[92:95], v[84:87], v[176:191]
    s_and_b32 s42, s42, 1023
    s_lshl_b32 s43, s42, 12
    s_waitcnt lgkmcnt(6)
    v_mfma_f32_32x32x16_bf16 v[128:143], v[104:107], v[96:99], v[128:143]
    ds_read_b128 v[80:83], v22
    ds_read_b128 v[84:87], v22 offset:4096
    v_mfma_f32_32x32x16_bf16 v[144:159], v[104:107], v[100:103], v[144:159]
    ds_read_b64_tr_b16 v[88:89], v28 offset:8192
    ds_read_b64_tr_b16 v[90:91], v28 offset:9216
    v_mfma_f32_32x32x16_bf16 v[160:175], v[108:111], v[96:99], v[160:175]
    ds_read_b64_tr_b16 v[92:93], v29 offset:8192
    ds_read_b64_tr_b16 v[94:95], v29 offset:9216
    v_mfma_f32_32x32x16_bf16 v[176:191], v[108:111], v[100:103], v[176:191]
    s_waitcnt lgkmcnt(6)
    v_mfma_f32_32x32x16_bf16 v[128:143], v[72:75], v[64:67], v[128:143]
    ds_read_b128 v[96:99], v23
    ds_read_b128 v[100:103], v23 offset:4096
    v_mfma_f32_32x32x16_bf16 v[144:159], v[72:75], v[68:71], v[144:159]
    ds_read_b64_tr_b16 v[104:105], v28 offset:12288
    ds_read_b64_tr_b16 v[106:107], v28 offset:13312
    v_mfma_f32_32x32x16_bf16 v[160:175], v[76:79], v[64:67], v[160:175]
    ds_read_b64_tr_b16 v[108:109], v29 offset:12288
    ds_read_b64_tr_b16 v[110:111], v29 offset:13312
    v_mfma_f32_32x32x16_bf16 v[176:191], v[76:79], v[68:71], v[176:191]
    s_waitcnt vmcnt(8) lgkmcnt(0)
    s_barrier
    v_mfma_f32_32x32x16_bf16 v[128:143], v[88:91], v[80:83], v[128:143]
    ds_read_b128 v[64:67], v12
    ds_read_b128 v[68:71], v12 offset:4096
    s_mov_b32 s12, s26
    s_mov_b32 s13, s27
    s_add_u32 m0, s45, 98304
    v_mfma_f32_32x32x16_bf16 v[144:159], v[88:91], v[84:87], v[144:159]
    ds_read_b64_tr_b16 v[72:73], v24 offset:0
    ds_read_b64_tr_b16 v[74:75], v24 offset:1024
    s_add_u32 s40, s42, 0
    buffer_load_dwordx4 v8, s[36:39], s40 offen offset:0 lds
    v_mfma_f32_32x32x16_bf16 v[160:175], v[92:95], v[80:83], v[160:175]
    ds_read_b64_tr_b16 v[76:77], v25 offset:0
    ds_read_b64_tr_b16 v[78:79], v25 offset:1024
    s_add_u32 s40, s42, 7168
    buffer_load_dwordx4 v9, s[36:39], s40 offen offset:1024 lds
    v_mfma_f32_32x32x16_bf16 v[176:191], v[92:95], v[84:87], v[176:191]
    s_add_u32 s40, s42, 14336
    buffer_load_dwordx4 v8, s[36:39], s40 offen offset:2048 lds
    s_waitcnt lgkmcnt(6)
    v_mfma_f32_32x32x16_bf16 v[128:143], v[104:107], v[96:99], v[128:143]
    ds_read_b128 v[80:83], v13
    ds_read_b128 v[84:87], v13 offset:4096
    s_add_u32 s40, s42, 21504
    buffer_load_dwordx4 v9, s[36:39], s40 offen offset:3072 lds
    s_add_u32 m0, s46, 98304
    v_mfma_f32_32x32x16_bf16 v[144:159], v[104:107], v[100:103], v[144:159]
    ds_read_b64_tr_b16 v[88:89], v24 offset:4096
    ds_read_b64_tr_b16 v[90:91], v24 offset:5120
    s_add_u32 s40, s43, 31744
    buffer_load_dwordx4 v10, s[12:15], s43 offen lds
    v_mfma_f32_32x32x16_bf16 v[160:175], v[108:111], v[96:99], v[160:175]
    ds_read_b64_tr_b16 v[92:93], v25 offset:4096
    ds_read_b64_tr_b16 v[94:95], v25 offset:5120
    buffer_load_dwordx4 v10, s[12:15], s40 offen offset:1024 lds
    s_add_u32 s42, s42, 128
    v_mfma_f32_32x32x16_bf16 v[176:191], v[108:111], v[100:103], v[176:191]
    s_and_b32 s42, s42, 1023
    s_lshl_b32 s43, s42, 12
    s_waitcnt lgkmcnt(6)
    v_mfma_f32_32x32x16_bf16 v[128:143], v[72:75], v[64:67], v[128:143]
    ds_read_b128 v[96:99], v14
    ds_read_b128 v[100:103], v14 offset:4096
    v_mfma_f32_32x32x16_bf16 v[144:159], v[72:75], v[68:71], v[144:159]
    ds_read_b64_tr_b16 v[104:105], v24 offset:8192
    ds_read_b64_tr_b16 v[106:107], v24 offset:9216
    v_mfma_f32_32x32x16_bf16 v[160:175], v[76:79], v[64:67], v[160:175]
    ds_read_b64_tr_b16 v[108:109], v25 offset:8192
    ds_read_b64_tr_b16 v[110:111], v25 offset:9216
    v_mfma_f32_32x32x16_bf16 v[176:191], v[76:79], v[68:71], v[176:191]
    s_waitcnt lgkmcnt(6)
    v_mfma_f32_32x32x16_bf16 v[128:143], v[88:91], v[80:83], v[128:143]
    ds_read_b128 v[64:67], v15
    ds_read_b128 v[68:71], v15 offset:4096
    v_mfma_f32_32x32x16_bf16 v[144:159], v[88:91], v[84:87], v[144:159]
    ds_read_b64_tr_b16 v[72:73], v24 offset:12288
    ds_read_b64_tr_b16 v[74:75], v24 offset:13312
    v_mfma_f32_32x32x16_bf16 v[160:175], v[92:95], v[80:83], v[160:175]
    ds_read_b64_tr_b16 v[76:77], v25 offset:12288
    ds_read_b64_tr_b16 v[78:79], v25 offset:13312
    v_mfma_f32_32x32x16_bf16 v[176:191], v[92:95], v[84:87], v[176:191]
    s_waitcnt vmcnt(6) lgkmcnt(0)
    s_barrier
    v_mfma_f32_32x32x16_bf16 v[128:143], v[104:107], v[96:99], v[128:143]
    ds_read_b128 v[80:83], v16
    ds_read_b128 v[84:87], v16 offset:4096
    s_add_u32 m0, s45, 0
    s_add_u32 s40, s42, 0
    v_mfma_f32_32x32x16_bf16 v[144:159], v[104:107], v[100:103], v[144:159]
    ds_read_b64_tr_b16 v[88:89], v26 offset:0
    ds_read_b64_tr_b16 v[90:91], v26 offset:1024
    buffer_load_dwordx4 v8, s[36:39], s40 offen offset:0 lds
    s_add_u32 s40, s42, 7168
    v_mfma_f32_32x32x16_bf16 v[160:175], v[108:111], v[96:99], v[160:175]
    ds_read_b64_tr_b16 v[92:93], v27 offset:0
    ds_read_b64_tr_b16 v[94:95], v27 offset:1024
    buffer_load_dwordx4 v9, s[36:39], s40 offen offset:1024 lds
    s_add_u32 s40, s42, 14336
    v_mfma_f32_32x32x16_bf16 v[176:191], v[108:111], v[100:103], v[176:191]
    buffer_load_dwordx4 v8, s[36:39], s40 offen offset:2048 lds
    s_add_u32 s40, s42, 21504
    s_waitcnt lgkmcnt(6)
    v_mfma_f32_32x32x16_bf16 v[128:143], v[72:75], v[64:67], v[128:143]
    ds_read_b128 v[96:99], v17
    ds_read_b128 v[100:103], v17 offset:4096
    buffer_load_dwordx4 v9, s[36:39], s40 offen offset:3072 lds
    s_add_u32 m0, s46, 0
    v_mfma_f32_32x32x16_bf16 v[144:159], v[72:75], v[68:71], v[144:159]
    ds_read_b64_tr_b16 v[104:105], v26 offset:4096
    ds_read_b64_tr_b16 v[106:107], v26 offset:5120
    s_add_u32 s40, s43, 31744
    buffer_load_dwordx4 v10, s[12:15], s43 offen lds
    v_mfma_f32_32x32x16_bf16 v[160:175], v[76:79], v[64:67], v[160:175]
    ds_read_b64_tr_b16 v[108:109], v27 offset:4096
    ds_read_b64_tr_b16 v[110:111], v27 offset:5120
    buffer_load_dwordx4 v10, s[12:15], s40 offen offset:1024 lds
    s_add_u32 s42, s42, 128
    v_mfma_f32_32x32x16_bf16 v[176:191], v[76:79], v[68:71], v[176:191]
    s_and_b32 s42, s42, 1023
    s_lshl_b32 s43, s42, 12
    s_waitcnt lgkmcnt(6)
    v_mfma_f32_32x32x16_bf16 v[128:143], v[88:91], v[80:83], v[128:143]
    ds_read_b128 v[64:67], v18
    ds_read_b128 v[68:71], v18 offset:4096
    v_mfma_f32_32x32x16_bf16 v[144:159], v[88:91], v[84:87], v[144:159]
    ds_read_b64_tr_b16 v[72:73], v26 offset:8192
    ds_read_b64_tr_b16 v[74:75], v26 offset:9216
    v_mfma_f32_32x32x16_bf16 v[160:175], v[92:95], v[80:83], v[160:175]
    ds_read_b64_tr_b16 v[76:77], v27 offset:8192
    ds_read_b64_tr_b16 v[78:79], v27 offset:9216
    v_mfma_f32_32x32x16_bf16 v[176:191], v[92:95], v[84:87], v[176:191]
    s_waitcnt lgkmcnt(6)
    v_mfma_f32_32x32x16_bf16 v[128:143], v[104:107], v[96:99], v[128:143]
    ds_read_b128 v[80:83], v19
    ds_read_b128 v[84:87], v19 offset:4096
    v_mfma_f32_32x32x16_bf16 v[144:159], v[104:107], v[100:103], v[144:159]
    ds_read_b64_tr_b16 v[88:89], v26 offset:12288
    ds_read_b64_tr_b16 v[90:91], v26 offset:13312
    v_mfma_f32_32x32x16_bf16 v[160:175], v[108:111], v[96:99], v[160:175]
    ds_read_b64_tr_b16 v[92:93], v27 offset:12288
    ds_read_b64_tr_b16 v[94:95], v27 offset:13312
    v_mfma_f32_32x32x16_bf16 v[176:191], v[108:111], v[100:103], v[176:191]
    s_waitcnt vmcnt(6) lgkmcnt(0)
    s_barrier
    v_mfma_f32_32x32x16_bf16 v[128:143], v[72:75], v[64:67], v[128:143]
    ds_read_b128 v[96:99], v20
    ds_read_b128 v[100:103], v20 offset:4096
    s_add_u32 m0, s45, 49152
    s_add_u32 s40, s42, 0
    v_mfma_f32_32x32x16_bf16 v[144:159], v[72:75], v[68:71], v[144:159]
    ds_read_b64_tr_b16 v[104:105], v28 offset:0
    ds_read_b64_tr_b16 v[106:107], v28 offset:1024
    buffer_load_dwordx4 v8, s[36:39], s40 offen offset:0 lds
    s_add_u32 s40, s42, 7168
    v_mfma_f32_32x32x16_bf16 v[160:175], v[76:79], v[64:67], v[160:175]
    ds_read_b64_tr_b16 v[108:109], v29 offset:0
    ds_read_b64_tr_b16 v[110:111], v29 offset:1024
    buffer_load_dwordx4 v9, s[36:39], s40 offen offset:1024 lds
    s_add_u32 s40, s42, 14336
    v_mfma_f32_32x32x16_bf16 v[176:191], v[76:79], v[68:71], v[176:191]
    buffer_load_dwordx4 v8, s[36:39], s40 offen offset:2048 lds
    s_add_u32 s40, s42, 21504
    s_waitcnt lgkmcnt(6)
    v_mfma_f32_32x32x16_bf16 v[128:143], v[88:91], v[80:83], v[128:143]
    ds_read_b128 v[64:67], v21
    ds_read_b128 v[68:71], v21 offset:4096
    buffer_load_dwordx4 v9, s[36:39], s40 offen offset:3072 lds
    s_add_u32 m0, s46, 49152
    v_mfma_f32_32x32x16_bf16 v[144:159], v[88:91], v[84:87], v[144:159]
    ds_read_b64_tr_b16 v[72:73], v28 offset:4096
    ds_read_b64_tr_b16 v[74:75], v28 offset:5120
    s_add_u32 s40, s43, 31744
    buffer_load_dwordx4 v10, s[12:15], s43 offen lds
    v_mfma_f32_32x32x16_bf16 v[160:175], v[92:95], v[80:83], v[160:175]
    ds_read_b64_tr_b16 v[76:77], v29 offset:4096
    ds_read_b64_tr_b16 v[78:79], v29 offset:5120
    buffer_load_dwordx4 v10, s[12:15], s40 offen offset:1024 lds
    s_add_u32 s42, s42, 128
    v_mfma_f32_32x32x16_bf16 v[176:191], v[92:95], v[84:87], v[176:191]
    s_and_b32 s42, s42, 1023
    s_lshl_b32 s43, s42, 12
    s_waitcnt lgkmcnt(6)
    v_mfma_f32_32x32x16_bf16 v[192:207], v[96:99], v[104:107], 0
    ds_read_b128 v[80:83], v22
    ds_read_b128 v[84:87], v22 offset:4096
    v_cvt_pk_bf16_f32 v32, v128, v129
    v_cvt_pk_bf16_f32 v33, v130, v131
    v_mfma_f32_32x32x16_bf16 v[208:223], v[100:103], v[104:107], 0
    ds_read_b64_tr_b16 v[88:89], v28 offset:8192
    ds_read_b64_tr_b16 v[90:91], v28 offset:9216
    v_cvt_pk_bf16_f32 v34, v132, v133
    v_mfma_f32_32x32x16_bf16 v[224:239], v[96:99], v[108:111], 0
    ds_read_b64_tr_b16 v[92:93], v29 offset:8192
    ds_read_b64_tr_b16 v[94:95], v29 offset:9216
    v_cvt_pk_bf16_f32 v35, v134, v135
    v_mfma_f32_32x32x16_bf16 v[240:255], v[100:103], v[108:111], 0
    buffer_store_dwordx4 v[32:35], v1, s[20:23], s48 offen offset:0 sc1
    s_waitcnt lgkmcnt(6)
    v_mfma_f32_32x32x16_bf16 v[192:207], v[64:67], v[72:75], v[192:207]
    ds_read_b128 v[96:99], v23
    ds_read_b128 v[100:103], v23 offset:4096
    v_cvt_pk_bf16_f32 v36, v136, v137
    v_cvt_pk_bf16_f32 v37, v138, v139
    v_mfma_f32_32x32x16_bf16 v[208:223], v[68:71], v[72:75], v[208:223]
    ds_read_b64_tr_b16 v[104:105], v28 offset:12288
    ds_read_b64_tr_b16 v[106:107], v28 offset:13312
    v_cvt_pk_bf16_f32 v38, v140, v141
    v_mfma_f32_32x32x16_bf16 v[224:239], v[64:67], v[76:79], v[224:239]
    ds_read_b64_tr_b16 v[108:109], v29 offset:12288
    ds_read_b64_tr_b16 v[110:111], v29 offset:13312
    v_cvt_pk_bf16_f32 v39, v142, v143
    v_mfma_f32_32x32x16_bf16 v[240:255], v[68:71], v[76:79], v[240:255]
    buffer_store_dwordx4 v[36:39], v1, s[20:23], s48 offen offset:1024 sc1
    s_waitcnt vmcnt(8) lgkmcnt(0)
    s_barrier
    v_mfma_f32_32x32x16_bf16 v[192:207], v[80:83], v[88:91], v[192:207]
    ds_read_b128 v[64:67], v12
    ds_read_b128 v[68:71], v12 offset:4096
    s_add_u32 m0, s45, 98304
    s_add_u32 s40, s42, 0
    v_mfma_f32_32x32x16_bf16 v[208:223], v[84:87], v[88:91], v[208:223]
    ds_read_b64_tr_b16 v[72:73], v24 offset:0
    ds_read_b64_tr_b16 v[74:75], v24 offset:1024
    buffer_load_dwordx4 v8, s[36:39], s40 offen offset:0 lds
    s_add_u32 s40, s42, 7168
    v_mfma_f32_32x32x16_bf16 v[224:239], v[80:83], v[92:95], v[224:239]
    ds_read_b64_tr_b16 v[76:77], v25 offset:0
    ds_read_b64_tr_b16 v[78:79], v25 offset:1024
    buffer_load_dwordx4 v9, s[36:39], s40 offen offset:1024 lds
    s_add_u32 s40, s42, 14336
    v_mfma_f32_32x32x16_bf16 v[240:255], v[84:87], v[92:95], v[240:255]
    buffer_load_dwordx4 v8, s[36:39], s40 offen offset:2048 lds
    s_add_u32 s40, s42, 21504
    s_waitcnt lgkmcnt(6)
    v_mfma_f32_32x32x16_bf16 v[192:207], v[96:99], v[104:107], v[192:207]
    ds_read_b128 v[80:83], v13
    ds_read_b128 v[84:87], v13 offset:4096
    buffer_load_dwordx4 v9, s[36:39], s40 offen offset:3072 lds
    s_add_u32 m0, s46, 98304
    v_mfma_f32_32x32x16_bf16 v[208:223], v[100:103], v[104:107], v[208:223]
    ds_read_b64_tr_b16 v[88:89], v24 offset:4096
    ds_read_b64_tr_b16 v[90:91], v24 offset:5120
    s_add_u32 s40, s43, 31744
    buffer_load_dwordx4 v10, s[12:15], s43 offen lds
    v_mfma_f32_32x32x16_bf16 v[224:239], v[96:99], v[108:111], v[224:239]
    ds_read_b64_tr_b16 v[92:93], v25 offset:4096
    ds_read_b64_tr_b16 v[94:95], v25 offset:5120
    buffer_load_dwordx4 v10, s[12:15], s40 offen offset:1024 lds
    s_add_u32 s42, s42, 128
    v_mfma_f32_32x32x16_bf16 v[240:255], v[100:103], v[108:111], v[240:255]
    s_and_b32 s42, s42, 1023
    s_lshl_b32 s43, s42, 12
    s_waitcnt lgkmcnt(6)
    v_mfma_f32_32x32x16_bf16 v[192:207], v[64:67], v[72:75], v[192:207]
    ds_read_b128 v[96:99], v14
    ds_read_b128 v[100:103], v14 offset:4096
    v_cvt_pk_bf16_f32 v40, v144, v145
    v_cvt_pk_bf16_f32 v41, v146, v147
    v_mfma_f32_32x32x16_bf16 v[208:223], v[68:71], v[72:75], v[208:223]
    ds_read_b64_tr_b16 v[104:105], v24 offset:8192
    ds_read_b64_tr_b16 v[106:107], v24 offset:9216
    v_cvt_pk_bf16_f32 v42, v148, v149
    v_mfma_f32_32x32x16_bf16 v[224:239], v[64:67], v[76:79], v[224:239]
    ds_read_b64_tr_b16 v[108:109], v25 offset:8192
    ds_read_b64_tr_b16 v[110:111], v25 offset:9216
    v_cvt_pk_bf16_f32 v43, v150, v151
    v_mfma_f32_32x32x16_bf16 v[240:255], v[68:71], v[76:79], v[240:255]
    buffer_store_dwordx4 v[40:43], v1, s[20:23], s49 offen offset:0 sc1
    s_waitcnt lgkmcnt(6)
    v_mfma_f32_32x32x16_bf16 v[192:207], v[80:83], v[88:91], v[192:207]
    ds_read_b128 v[64:67], v15
    ds_read_b128 v[68:71], v15 offset:4096
    v_cvt_pk_bf16_f32 v44, v152, v153
    v_cvt_pk_bf16_f32 v45, v154, v155
    v_mfma_f32_32x32x16_bf16 v[208:223], v[84:87], v[88:91], v[208:223]
    ds_read_b64_tr_b16 v[72:73], v24 offset:12288
    ds_read_b64_tr_b16 v[74:75], v24 offset:13312
    v_cvt_pk_bf16_f32 v46, v156, v157
    v_mfma_f32_32x32x16_bf16 v[224:239], v[80:83], v[92:95], v[224:239]
    ds_read_b64_tr_b16 v[76:77], v25 offset:12288
    ds_read_b64_tr_b16 v[78:79], v25 offset:13312
    v_cvt_pk_bf16_f32 v47, v158, v159
    v_mfma_f32_32x32x16_bf16 v[240:255], v[84:87], v[92:95], v[240:255]
    buffer_store_dwordx4 v[44:47], v1, s[20:23], s49 offen offset:1024 sc1
    s_waitcnt vmcnt(10) lgkmcnt(0)
    s_barrier
    v_mfma_f32_32x32x16_bf16 v[192:207], v[96:99], v[104:107], v[192:207]
    ds_read_b128 v[80:83], v16
    ds_read_b128 v[84:87], v16 offset:4096
    s_add_u32 m0, s45, 0
    s_add_u32 s40, s42, 0
    v_mfma_f32_32x32x16_bf16 v[208:223], v[100:103], v[104:107], v[208:223]
    ds_read_b64_tr_b16 v[88:89], v26 offset:0
    ds_read_b64_tr_b16 v[90:91], v26 offset:1024
    buffer_load_dwordx4 v8, s[36:39], s40 offen offset:0 lds
    s_add_u32 s40, s42, 7168
    v_mfma_f32_32x32x16_bf16 v[224:239], v[96:99], v[108:111], v[224:239]
    ds_read_b64_tr_b16 v[92:93], v27 offset:0
    ds_read_b64_tr_b16 v[94:95], v27 offset:1024
    buffer_load_dwordx4 v9, s[36:39], s40 offen offset:1024 lds
    s_add_u32 s40, s42, 14336
    v_mfma_f32_32x32x16_bf16 v[240:255], v[100:103], v[108:111], v[240:255]
    buffer_load_dwordx4 v8, s[36:39], s40 offen offset:2048 lds
    s_add_u32 s40, s42, 21504
    s_waitcnt lgkmcnt(6)
    v_mfma_f32_32x32x16_bf16 v[192:207], v[64:67], v[72:75], v[192:207]
    ds_read_b128 v[96:99], v17
    ds_read_b128 v[100:103], v17 offset:4096
    buffer_load_dwordx4 v9, s[36:39], s40 offen offset:3072 lds
    s_add_u32 m0, s46, 0
    v_mfma_f32_32x32x16_bf16 v[208:223], v[68:71], v[72:75], v[208:223]
    ds_read_b64_tr_b16 v[104:105], v26 offset:4096
    ds_read_b64_tr_b16 v[106:107], v26 offset:5120
    s_add_u32 s40, s43, 31744
    buffer_load_dwordx4 v10, s[12:15], s43 offen lds
    v_mfma_f32_32x32x16_bf16 v[224:239], v[64:67], v[76:79], v[224:239]
    ds_read_b64_tr_b16 v[108:109], v27 offset:4096
    ds_read_b64_tr_b16 v[110:111], v27 offset:5120
    buffer_load_dwordx4 v10, s[12:15], s40 offen offset:1024 lds
    s_add_u32 s42, s42, 128
    v_mfma_f32_32x32x16_bf16 v[240:255], v[68:71], v[76:79], v[240:255]
    s_and_b32 s42, s42, 1023
    s_lshl_b32 s43, s42, 12
    s_waitcnt lgkmcnt(6)
    v_mfma_f32_32x32x16_bf16 v[192:207], v[80:83], v[88:91], v[192:207]
    ds_read_b128 v[64:67], v18
    ds_read_b128 v[68:71], v18 offset:4096
    v_cvt_pk_bf16_f32 v48, v160, v161
    v_cvt_pk_bf16_f32 v49, v162, v163
    v_mfma_f32_32x32x16_bf16 v[208:223], v[84:87], v[88:91], v[208:223]
    ds_read_b64_tr_b16 v[72:73], v26 offset:8192
    ds_read_b64_tr_b16 v[74:75], v26 offset:9216
    v_cvt_pk_bf16_f32 v50, v164, v165
    v_mfma_f32_32x32x16_bf16 v[224:239], v[80:83], v[92:95], v[224:239]
    ds_read_b64_tr_b16 v[76:77], v27 offset:8192
    ds_read_b64_tr_b16 v[78:79], v27 offset:9216
    v_cvt_pk_bf16_f32 v51, v166, v167
    v_mfma_f32_32x32x16_bf16 v[240:255], v[84:87], v[92:95], v[240:255]
    buffer_store_dwordx4 v[48:51], v1, s[20:23], s48 offen offset:2048 sc1
    s_waitcnt lgkmcnt(6)
    v_mfma_f32_32x32x16_bf16 v[192:207], v[96:99], v[104:107], v[192:207]
    ds_read_b128 v[80:83], v19
    ds_read_b128 v[84:87], v19 offset:4096
    v_cvt_pk_bf16_f32 v52, v168, v169
    v_cvt_pk_bf16_f32 v53, v170, v171
    v_mfma_f32_32x32x16_bf16 v[208:223], v[100:103], v[104:107], v[208:223]
    ds_read_b64_tr_b16 v[88:89], v26 offset:12288
    ds_read_b64_tr_b16 v[90:91], v26 offset:13312
    v_cvt_pk_bf16_f32 v54, v172, v173
    v_mfma_f32_32x32x16_bf16 v[224:239], v[96:99], v[108:111], v[224:239]
    ds_read_b64_tr_b16 v[92:93], v27 offset:12288
    ds_read_b64_tr_b16 v[94:95], v27 offset:13312
    v_cvt_pk_bf16_f32 v55, v174, v175
    v_mfma_f32_32x32x16_bf16 v[240:255], v[100:103], v[108:111], v[240:255]
    buffer_store_dwordx4 v[52:55], v1, s[20:23], s48 offen offset:3072 sc1
    s_waitcnt vmcnt(10) lgkmcnt(0)
    s_barrier
    v_mfma_f32_32x32x16_bf16 v[192:207], v[64:67], v[72:75], v[192:207]
    ds_read_b128 v[96:99], v20
    ds_read_b128 v[100:103], v20 offset:4096
    s_add_u32 m0, s45, 49152
    s_add_u32 s40, s42, 0
    v_mfma_f32_32x32x16_bf16 v[208:223], v[68:71], v[72:75], v[208:223]
    ds_read_b64_tr_b16 v[104:105], v28 offset:0
    ds_read_b64_tr_b16 v[106:107], v28 offset:1024
    buffer_load_dwordx4 v8, s[36:39], s40 offen offset:0 lds
    s_add_u32 s40, s42, 7168
    v_mfma_f32_32x32x16_bf16 v[224:239], v[64:67], v[76:79], v[224:239]
    ds_read_b64_tr_b16 v[108:109], v29 offset:0
    ds_read_b64_tr_b16 v[110:111], v29 offset:1024
    buffer_load_dwordx4 v9, s[36:39], s40 offen offset:1024 lds
    s_add_u32 s40, s42, 14336
    v_mfma_f32_32x32x16_bf16 v[240:255], v[68:71], v[76:79], v[240:255]
    buffer_load_dwordx4 v8, s[36:39], s40 offen offset:2048 lds
    s_add_u32 s40, s42, 21504
    s_waitcnt lgkmcnt(6)
    v_mfma_f32_32x32x16_bf16 v[192:207], v[80:83], v[88:91], v[192:207]
    ds_read_b128 v[64:67], v21
    ds_read_b128 v[68:71], v21 offset:4096
    buffer_load_dwordx4 v9, s[36:39], s40 offen offset:3072 lds
    s_add_u32 m0, s46, 49152
    v_mfma_f32_32x32x16_bf16 v[208:223], v[84:87], v[88:91], v[208:223]
    ds_read_b64_tr_b16 v[72:73], v28 offset:4096
    ds_read_b64_tr_b16 v[74:75], v28 offset:5120
    s_add_u32 s40, s43, 31744
    buffer_load_dwordx4 v10, s[12:15], s43 offen lds
    v_mfma_f32_32x32x16_bf16 v[224:239], v[80:83], v[92:95], v[224:239]
    ds_read_b64_tr_b16 v[76:77], v29 offset:4096
    ds_read_b64_tr_b16 v[78:79], v29 offset:5120
    buffer_load_dwordx4 v10, s[12:15], s40 offen offset:1024 lds
    s_add_u32 s42, s42, 128
    v_mfma_f32_32x32x16_bf16 v[240:255], v[84:87], v[92:95], v[240:255]
    s_and_b32 s42, s42, 1023
    s_lshl_b32 s43, s42, 12
    s_waitcnt lgkmcnt(6)
    v_mfma_f32_32x32x16_bf16 v[192:207], v[96:99], v[104:107], v[192:207]
    ds_read_b128 v[80:83], v22
    ds_read_b128 v[84:87], v22 offset:4096
    s_lshl_b32 s28, s2, 3
    s_add_u32 s28, s28, s3
    s_lshl_b32 s28, s28, 11
    v_and_b32 v4, 15, v0
    v_lshlrev_b32 v4, 7, v4
    v_mfma_f32_32x32x16_bf16 v[208:223], v[100:103], v[104:107], v[208:223]
    ds_read_b64_tr_b16 v[88:89], v28 offset:8192
    ds_read_b64_tr_b16 v[90:91], v28 offset:9216
    s_mov_b32 s92, s56
    s_mov_b32 s93, s57
    buffer_load_dword v114, v4, s[92:95], s28 offen
    s_mov_b32 s92, s58
    s_mov_b32 s93, s59
    v_mfma_f32_32x32x16_bf16 v[224:239], v[96:99], v[108:111], v[224:239]
    ds_read_b64_tr_b16 v[92:93], v29 offset:8192
    ds_read_b64_tr_b16 v[94:95], v29 offset:9216
    s_mov_b32 s94, 524288
    buffer_load_dword v115, v4, s[92:95], s28 offen
    s_mov_b32 s92, s60
    s_mov_b32 s93, s61
    buffer_load_dword v116, v4, s[92:95], s28 offen
    v_mfma_f32_32x32x16_bf16 v[240:255], v[100:103], v[108:111], v[240:255]
    v_cvt_pk_bf16_f32 v56, v176, v177
    v_cvt_pk_bf16_f32 v57, v178, v179
    v_cvt_pk_bf16_f32 v58, v180, v181
    v_cvt_pk_bf16_f32 v59, v182, v183
    buffer_store_dwordx4 v[56:59], v1, s[20:23], s49 offen offset:2048 sc1
    s_waitcnt lgkmcnt(6)
    v_mfma_f32_32x32x16_bf16 v[192:207], v[64:67], v[72:75], v[192:207]
    ds_read_b128 v[96:99], v23
    ds_read_b128 v[100:103], v23 offset:4096
    v_cvt_pk_bf16_f32 v60, v184, v185
    v_cvt_pk_bf16_f32 v61, v186, v187
    v_mfma_f32_32x32x16_bf16 v[208:223], v[68:71], v[72:75], v[208:223]
    ds_read_b64_tr_b16 v[104:105], v28 offset:12288
    ds_read_b64_tr_b16 v[106:107], v28 offset:13312
    v_cvt_pk_bf16_f32 v62, v188, v189
    v_mfma_f32_32x32x16_bf16 v[224:239], v[64:67], v[76:79], v[224:239]
    ds_read_b64_tr_b16 v[108:109], v29 offset:12288
    ds_read_b64_tr_b16 v[110:111], v29 offset:13312
    v_cvt_pk_bf16_f32 v63, v190, v191
    v_mfma_f32_32x32x16_bf16 v[240:255], v[68:71], v[76:79], v[240:255]
    buffer_store_dwordx4 v[60:63], v1, s[20:23], s49 offen offset:3072 sc1
    s_waitcnt vmcnt(13) lgkmcnt(0)
    s_barrier
    v_mfma_f32_32x32x16_bf16 v[192:207], v[80:83], v[88:91], v[192:207]
    ds_read_b128 v[64:67], v12
    ds_read_b128 v[68:71], v12 offset:4096
    s_add_u32 m0, s45, 98304
    s_add_u32 s40, s42, 0
    v_mfma_f32_32x32x16_bf16 v[208:223], v[84:87], v[88:91], v[208:223]
    ds_read_b64_tr_b16 v[72:73], v24 offset:0
    ds_read_b64_tr_b16 v[74:75], v24 offset:1024
    buffer_load_dwordx4 v8, s[36:39], s40 offen offset:0 lds
    s_add_u32 s40, s42, 7168
    v_mfma_f32_32x32x16_bf16 v[224:239], v[80:83], v[92:95], v[224:239]
    ds_read_b64_tr_b16 v[76:77], v25 offset:0
    ds_read_b64_tr_b16 v[78:79], v25 offset:1024
    buffer_load_dwordx4 v9, s[36:39], s40 offen offset:1024 lds
    s_add_u32 s40, s42, 14336
    v_mfma_f32_32x32x16_bf16 v[240:255], v[84:87], v[92:95], v[240:255]
    buffer_load_dwordx4 v8, s[36:39], s40 offen offset:2048 lds
    s_add_u32 s40, s42, 21504
    s_waitcnt lgkmcnt(6)
    v_mfma_f32_32x32x16_bf16 v[192:207], v[96:99], v[104:107], v[192:207]
    ds_read_b128 v[80:83], v13
    ds_read_b128 v[84:87], v13 offset:4096
    buffer_load_dwordx4 v9, s[36:39], s40 offen offset:3072 lds
    s_add_u32 m0, s46, 98304
    v_mfma_f32_32x32x16_bf16 v[208:223], v[100:103], v[104:107], v[208:223]
    ds_read_b64_tr_b16 v[88:89], v24 offset:4096
    ds_read_b64_tr_b16 v[90:91], v24 offset:5120
    s_add_u32 s40, s43, 31744
    buffer_load_dwordx4 v10, s[12:15], s43 offen lds
    v_mfma_f32_32x32x16_bf16 v[224:239], v[96:99], v[108:111], v[224:239]
    ds_read_b64_tr_b16 v[92:93], v25 offset:4096
    ds_read_b64_tr_b16 v[94:95], v25 offset:5120
    buffer_load_dwordx4 v10, s[12:15], s40 offen offset:1024 lds
    s_add_u32 s42, s42, 128
    v_mfma_f32_32x32x16_bf16 v[240:255], v[100:103], v[108:111], v[240:255]
    s_and_b32 s42, s42, 1023
    s_lshl_b32 s43, s42, 12
    s_waitcnt lgkmcnt(6)
    v_mfma_f32_32x32x16_bf16 v[192:207], v[64:67], v[72:75], v[192:207]
    ds_read_b128 v[96:99], v14
    ds_read_b128 v[100:103], v14 offset:4096
    v_mfma_f32_32x32x16_bf16 v[208:223], v[68:71], v[72:75], v[208:223]
    ds_read_b64_tr_b16 v[104:105], v24 offset:8192
    ds_read_b64_tr_b16 v[106:107], v24 offset:9216
    v_mfma_f32_32x32x16_bf16 v[224:239], v[64:67], v[76:79], v[224:239]
    ds_read_b64_tr_b16 v[108:109], v25 offset:8192
    ds_read_b64_tr_b16 v[110:111], v25 offset:9216
    v_mfma_f32_32x32x16_bf16 v[240:255], v[68:71], v[76:79], v[240:255]
    s_waitcnt lgkmcnt(6)
    v_mfma_f32_32x32x16_bf16 v[192:207], v[80:83], v[88:91], v[192:207]
    ds_read_b128 v[64:67], v15
    ds_read_b128 v[68:71], v15 offset:4096
    v_mfma_f32_32x32x16_bf16 v[208:223], v[84:87], v[88:91], v[208:223]
    ds_read_b64_tr_b16 v[72:73], v24 offset:12288
    ds_read_b64_tr_b16 v[74:75], v24 offset:13312
    v_mfma_f32_32x32x16_bf16 v[224:239], v[80:83], v[92:95], v[224:239]
    ds_read_b64_tr_b16 v[76:77], v25 offset:12288
    ds_read_b64_tr_b16 v[78:79], v25 offset:13312
    v_mfma_f32_32x32x16_bf16 v[240:255], v[84:87], v[92:95], v[240:255]
    s_waitcnt vmcnt(11) lgkmcnt(0)
    s_barrier
    v_mfma_f32_32x32x16_bf16 v[192:207], v[96:99], v[104:107], v[192:207]
    ds_read_b128 v[80:83], v16
    ds_read_b128 v[84:87], v16 offset:4096
    s_add_u32 m0, s45, 0
    s_add_u32 s40, s42, 0
    v_mfma_f32_32x32x16_bf16 v[208:223], v[100:103], v[104:107], v[208:223]
    ds_read_b64_tr_b16 v[88:89], v26 offset:0
    ds_read_b64_tr_b16 v[90:91], v26 offset:1024
    buffer_load_dwordx4 v8, s[36:39], s40 offen offset:0 lds
    s_add_u32 s40, s42, 7168
    v_mfma_f32_32x32x16_bf16 v[224:239], v[96:99], v[108:111], v[224:239]
    ds_read_b64_tr_b16 v[92:93], v27 offset:0
    ds_read_b64_tr_b16 v[94:95], v27 offset:1024
    buffer_load_dwordx4 v9, s[36:39], s40 offen offset:1024 lds
    s_add_u32 s40, s42, 14336
    v_mfma_f32_32x32x16_bf16 v[240:255], v[100:103], v[108:111], v[240:255]
    buffer_load_dwordx4 v8, s[36:39], s40 offen offset:2048 lds
    s_add_u32 s40, s42, 21504
    s_waitcnt lgkmcnt(6)
    v_mfma_f32_32x32x16_bf16 v[192:207], v[64:67], v[72:75], v[192:207]
    ds_read_b128 v[96:99], v17
    ds_read_b128 v[100:103], v17 offset:4096
    buffer_load_dwordx4 v9, s[36:39], s40 offen offset:3072 lds
    s_add_u32 m0, s46, 0
    v_mfma_f32_32x32x16_bf16 v[208:223], v[68:71], v[72:75], v[208:223]
    ds_read_b64_tr_b16 v[104:105], v26 offset:4096
    ds_read_b64_tr_b16 v[106:107], v26 offset:5120
    s_add_u32 s40, s43, 31744
    buffer_load_dwordx4 v10, s[12:15], s43 offen lds
    v_mfma_f32_32x32x16_bf16 v[224:239], v[64:67], v[76:79], v[224:239]
    ds_read_b64_tr_b16 v[108:109], v27 offset:4096
    ds_read_b64_tr_b16 v[110:111], v27 offset:5120
    buffer_load_dwordx4 v10, s[12:15], s40 offen offset:1024 lds
    s_add_u32 s42, s42, 128
    v_mfma_f32_32x32x16_bf16 v[240:255], v[68:71], v[76:79], v[240:255]
    s_and_b32 s42, s42, 1023
    s_lshl_b32 s43, s42, 12
    s_waitcnt lgkmcnt(6)
    v_mfma_f32_32x32x16_bf16 v[192:207], v[80:83], v[88:91], v[192:207]
    ds_read_b128 v[64:67], v18
    ds_read_b128 v[68:71], v18 offset:4096
    v_mfma_f32_32x32x16_bf16 v[208:223], v[84:87], v[88:91], v[208:223]
    ds_read_b64_tr_b16 v[72:73], v26 offset:8192
    ds_read_b64_tr_b16 v[74:75], v26 offset:9216
    v_mfma_f32_32x32x16_bf16 v[224:239], v[80:83], v[92:95], v[224:239]
    ds_read_b64_tr_b16 v[76:77], v27 offset:8192
    ds_read_b64_tr_b16 v[78:79], v27 offset:9216
    v_mfma_f32_32x32x16_bf16 v[240:255], v[84:87], v[92:95], v[240:255]
    s_waitcnt lgkmcnt(6)
    v_mfma_f32_32x32x16_bf16 v[192:207], v[96:99], v[104:107], v[192:207]
    ds_read_b128 v[80:83], v19
    ds_read_b128 v[84:87], v19 offset:4096
    v_mfma_f32_32x32x16_bf16 v[208:223], v[100:103], v[104:107], v[208:223]
    ds_read_b64_tr_b16 v[88:89], v26 offset:12288
    ds_read_b64_tr_b16 v[90:91], v26 offset:13312
    v_mfma_f32_32x32x16_bf16 v[224:239], v[96:99], v[108:111], v[224:239]
    ds_read_b64_tr_b16 v[92:93], v27 offset:12288
    ds_read_b64_tr_b16 v[94:95], v27 offset:13312
    v_mfma_f32_32x32x16_bf16 v[240:255], v[100:103], v[108:111], v[240:255]
    s_waitcnt vmcnt(6) lgkmcnt(0)
    s_barrier
    v_mfma_f32_32x32x16_bf16 v[192:207], v[64:67], v[72:75], v[192:207]
    ds_read_b128 v[96:99], v20
    ds_read_b128 v[100:103], v20 offset:4096
    s_mov_b32 s12, s54
    s_mov_b32 s13, s55
    s_mov_b32 s36, s64
    v_mfma_f32_32x32x16_bf16 v[208:223], v[68:71], v[72:75], v[208:223]
    ds_read_b64_tr_b16 v[104:105], v28 offset:0
    ds_read_b64_tr_b16 v[106:107], v28 offset:1024
    s_mov_b32 s37, s65
    v_mov_b32 v8, v112
    v_mov_b32 v9, v113
    v_mfma_f32_32x32x16_bf16 v[224:239], v[64:67], v[76:79], v[224:239]
    ds_read_b64_tr_b16 v[108:109], v29 offset:0
    ds_read_b64_tr_b16 v[110:111], v29 offset:1024
    s_add_u32 m0, s45, 49152
    s_add_u32 s40, s42, 0
    buffer_load_dwordx4 v8, s[36:39], s40 offen offset:0 lds
    v_mfma_f32_32x32x16_bf16 v[240:255], v[68:71], v[76:79], v[240:255]
    s_add_u32 s40, s42, 7168
    buffer_load_dwordx4 v9, s[36:39], s40 offen offset:1024 lds
    s_waitcnt lgkmcnt(6)
    v_mfma_f32_32x32x16_bf16 v[192:207], v[80:83], v[88:91], v[192:207]
    ds_read_b128 v[64:67], v21
    ds_read_b128 v[68:71], v21 offset:4096
    s_add_u32 s40, s42, 14336
    buffer_load_dwordx4 v8, s[36:39], s40 offen offset:2048 lds
    s_add_u32 s40, s42, 21504
    v_mfma_f32_32x32x16_bf16 v[208:223], v[84:87], v[88:91], v[208:223]
    ds_read_b64_tr_b16 v[72:73], v28 offset:4096
    ds_read_b64_tr_b16 v[74:75], v28 offset:5120
    buffer_load_dwordx4 v9, s[36:39], s40 offen offset:3072 lds
    s_add_u32 m0, s46, 49152
    s_add_u32 s40, s43, 31744
    v_mfma_f32_32x32x16_bf16 v[224:239], v[80:83], v[92:95], v[224:239]
    ds_read_b64_tr_b16 v[76:77], v29 offset:4096
    ds_read_b64_tr_b16 v[78:79], v29 offset:5120
    buffer_load_dwordx4 v10, s[12:15], s43 offen lds
    buffer_load_dwordx4 v10, s[12:15], s40 offen offset:1024 lds
    s_add_u32 s42, s42, 128
    v_mfma_f32_32x32x16_bf16 v[240:255], v[84:87], v[92:95], v[240:255]
    s_and_b32 s42, s42, 1023
    s_lshl_b32 s43, s42, 12
    s_waitcnt lgkmcnt(6)
    v_mfma_f32_32x32x16_bf16 v[192:207], v[96:99], v[104:107], v[192:207]
    ds_read_b128 v[80:83], v22
    ds_read_b128 v[84:87], v22 offset:4096
    v_mfma_f32_32x32x16_bf16 v[208:223], v[100:103], v[104:107], v[208:223]
    ds_read_b64_tr_b16 v[88:89], v28 offset:8192
    ds_read_b64_tr_b16 v[90:91], v28 offset:9216
    v_mfma_f32_32x32x16_bf16 v[224:239], v[96:99], v[108:111], v[224:239]
    ds_read_b64_tr_b16 v[92:93], v29 offset:8192
    ds_read_b64_tr_b16 v[94:95], v29 offset:9216
    v_mfma_f32_32x32x16_bf16 v[240:255], v[100:103], v[108:111], v[240:255]
    s_waitcnt lgkmcnt(6)
    v_mfma_f32_32x32x16_bf16 v[192:207], v[64:67], v[72:75], v[192:207]
    ds_read_b128 v[96:99], v23
    ds_read_b128 v[100:103], v23 offset:4096
    v_mfma_f32_32x32x16_bf16 v[208:223], v[68:71], v[72:75], v[208:223]
    ds_read_b64_tr_b16 v[104:105], v28 offset:12288
    ds_read_b64_tr_b16 v[106:107], v28 offset:13312
    v_mfma_f32_32x32x16_bf16 v[224:239], v[64:67], v[76:79], v[224:239]
    ds_read_b64_tr_b16 v[108:109], v29 offset:12288
    ds_read_b64_tr_b16 v[110:111], v29 offset:13312
    v_mfma_f32_32x32x16_bf16 v[240:255], v[68:71], v[76:79], v[240:255]
    s_waitcnt vmcnt(6) lgkmcnt(0)
    s_barrier
    v_mfma_f32_32x32x16_bf16 v[192:207], v[80:83], v[88:91], v[192:207]
    ds_read_b128 v[64:67], v12
    ds_read_b128 v[68:71], v12 offset:4096
    s_add_u32 m0, s45, 98304
    s_add_u32 s40, s42, 0
    v_mfma_f32_32x32x16_bf16 v[208:223], v[84:87], v[88:91], v[208:223]
    ds_read_b64_tr_b16 v[72:73], v24 offset:0
    ds_read_b64_tr_b16 v[74:75], v24 offset:1024
    buffer_load_dwordx4 v8, s[36:39], s40 offen offset:0 lds
    s_add_u32 s40, s42, 7168
    v_mfma_f32_32x32x16_bf16 v[224:239], v[80:83], v[92:95], v[224:239]
    ds_read_b64_tr_b16 v[76:77], v25 offset:0
    ds_read_b64_tr_b16 v[78:79], v25 offset:1024
    buffer_load_dwordx4 v9, s[36:39], s40 offen offset:1024 lds
    s_add_u32 s40, s42, 14336
    v_mfma_f32_32x32x16_bf16 v[240:255], v[84:87], v[92:95], v[240:255]
    buffer_load_dwordx4 v8, s[36:39], s40 offen offset:2048 lds
    s_add_u32 s40, s42, 21504
    s_waitcnt lgkmcnt(6)
    v_mfma_f32_32x32x16_bf16 v[192:207], v[96:99], v[104:107], v[192:207]
    ds_read_b128 v[80:83], v13
    ds_read_b128 v[84:87], v13 offset:4096
    buffer_load_dwordx4 v9, s[36:39], s40 offen offset:3072 lds
    s_add_u32 m0, s46, 98304
    v_mfma_f32_32x32x16_bf16 v[208:223], v[100:103], v[104:107], v[208:223]
    ds_read_b64_tr_b16 v[88:89], v24 offset:4096
    ds_read_b64_tr_b16 v[90:91], v24 offset:5120
    s_add_u32 s40, s43, 31744
    buffer_load_dwordx4 v10, s[12:15], s43 offen lds
    v_mfma_f32_32x32x16_bf16 v[224:239], v[96:99], v[108:111], v[224:239]
    ds_read_b64_tr_b16 v[92:93], v25 offset:4096
    ds_read_b64_tr_b16 v[94:95], v25 offset:5120
    buffer_load_dwordx4 v10, s[12:15], s40 offen offset:1024 lds
    s_add_u32 s42, s42, 128
    v_mfma_f32_32x32x16_bf16 v[240:255], v[100:103], v[108:111], v[240:255]
    s_and_b32 s42, s42, 1023
    s_lshl_b32 s43, s42, 12
    s_waitcnt lgkmcnt(6)
    v_mfma_f32_32x32x16_bf16 v[192:207], v[64:67], v[72:75], v[192:207]
    ds_read_b128 v[96:99], v14
    ds_read_b128 v[100:103], v14 offset:4096
    v_mfma_f32_32x32x16_bf16 v[208:223], v[68:71], v[72:75], v[208:223]
    ds_read_b64_tr_b16 v[104:105], v24 offset:8192
    ds_read_b64_tr_b16 v[106:107], v24 offset:9216
    v_mfma_f32_32x32x16_bf16 v[224:239], v[64:67], v[76:79], v[224:239]
    ds_read_b64_tr_b16 v[108:109], v25 offset:8192
    ds_read_b64_tr_b16 v[110:111], v25 offset:9216
    v_mfma_f32_32x32x16_bf16 v[240:255], v[68:71], v[76:79], v[240:255]
    s_waitcnt lgkmcnt(6)
    v_mfma_f32_32x32x16_bf16 v[192:207], v[80:83], v[88:91], v[192:207]
    ds_read_b128 v[64:67], v15
    ds_read_b128 v[68:71], v15 offset:4096
    v_mfma_f32_32x32x16_bf16 v[208:223], v[84:87], v[88:91], v[208:223]
    ds_read_b64_tr_b16 v[72:73], v24 offset:12288
    ds_read_b64_tr_b16 v[74:75], v24 offset:13312
    v_mfma_f32_32x32x16_bf16 v[224:239], v[80:83], v[92:95], v[224:239]
    ds_read_b64_tr_b16 v[76:77], v25 offset:12288
    ds_read_b64_tr_b16 v[78:79], v25 offset:13312
    v_mfma_f32_32x32x16_bf16 v[240:255], v[84:87], v[92:95], v[240:255]
    s_waitcnt vmcnt(6) lgkmcnt(0)
    s_barrier
    v_mfma_f32_32x32x16_bf16 v[192:207], v[96:99], v[104:107], v[192:207]
    ds_read_b128 v[80:83], v16
    ds_read_b128 v[84:87], v16 offset:4096
    s_add_u32 m0, s45, 0
    s_add_u32 s40, s42, 0
    v_mfma_f32_32x32x16_bf16 v[208:223], v[100:103], v[104:107], v[208:223]
    ds_read_b64_tr_b16 v[88:89], v26 offset:0
    ds_read_b64_tr_b16 v[90:91], v26 offset:1024
    buffer_load_dwordx4 v8, s[36:39], s40 offen offset:0 lds
    s_add_u32 s40, s42, 7168
    v_mfma_f32_32x32x16_bf16 v[224:239], v[96:99], v[108:111], v[224:239]
    ds_read_b64_tr_b16 v[92:93], v27 offset:0
    ds_read_b64_tr_b16 v[94:95], v27 offset:1024
    buffer_load_dwordx4 v9, s[36:39], s40 offen offset:1024 lds
    s_add_u32 s40, s42, 14336
    v_mfma_f32_32x32x16_bf16 v[240:255], v[100:103], v[108:111], v[240:255]
    buffer_load_dwordx4 v8, s[36:39], s40 offen offset:2048 lds
    s_add_u32 s40, s42, 21504
    s_waitcnt lgkmcnt(6)
    v_mfma_f32_32x32x16_bf16 v[192:207], v[64:67], v[72:75], v[192:207]
    ds_read_b128 v[96:99], v17
    ds_read_b128 v[100:103], v17 offset:4096
    buffer_load_dwordx4 v9, s[36:39], s40 offen offset:3072 lds
    s_add_u32 m0, s46, 0
    v_mfma_f32_32x32x16_bf16 v[208:223], v[68:71], v[72:75], v[208:223]
    ds_read_b64_tr_b16 v[104:105], v26 offset:4096
    ds_read_b64_tr_b16 v[106:107], v26 offset:5120
    s_add_u32 s40, s43, 31744
    buffer_load_dwordx4 v10, s[12:15], s43 offen lds
    v_mfma_f32_32x32x16_bf16 v[224:239], v[64:67], v[76:79], v[224:239]
    ds_read_b64_tr_b16 v[108:109], v27 offset:4096
    ds_read_b64_tr_b16 v[110:111], v27 offset:5120
    buffer_load_dwordx4 v10, s[12:15], s40 offen offset:1024 lds
    s_add_u32 s42, s42, 128
    v_mfma_f32_32x32x16_bf16 v[240:255], v[68:71], v[76:79], v[240:255]
    s_and_b32 s42, s42, 1023
    s_lshl_b32 s43, s42, 12
    s_waitcnt lgkmcnt(6)
    v_mfma_f32_32x32x16_bf16 v[128:143], v[88:91], v[80:83], 0
    ds_read_b128 v[64:67], v18
    ds_read_b128 v[68:71], v18 offset:4096
    v_cvt_pk_bf16_f32 v32, v192, v193
    v_cvt_pk_bf16_f32 v33, v194, v195
    v_mfma_f32_32x32x16_bf16 v[144:159], v[88:91], v[84:87], 0
    ds_read_b64_tr_b16 v[72:73], v26 offset:8192
    ds_read_b64_tr_b16 v[74:75], v26 offset:9216
    v_cvt_pk_bf16_f32 v34, v196, v197
    v_mfma_f32_32x32x16_bf16 v[160:175], v[92:95], v[80:83], 0
    ds_read_b64_tr_b16 v[76:77], v27 offset:8192
    ds_read_b64_tr_b16 v[78:79], v27 offset:9216
    v_cvt_pk_bf16_f32 v35, v198, v199
    v_mfma_f32_32x32x16_bf16 v[176:191], v[92:95], v[84:87], 0
    buffer_store_dwordx4 v[32:35], v1, s[20:23], s50 offen offset:0 sc1
    s_waitcnt lgkmcnt(6)
    v_mfma_f32_32x32x16_bf16 v[128:143], v[104:107], v[96:99], v[128:143]
    ds_read_b128 v[80:83], v19
    ds_read_b128 v[84:87], v19 offset:4096
    v_cvt_pk_bf16_f32 v36, v200, v201
    v_cvt_pk_bf16_f32 v37, v202, v203
    v_mfma_f32_32x32x16_bf16 v[144:159], v[104:107], v[100:103], v[144:159]
    ds_read_b64_tr_b16 v[88:89], v26 offset:12288
    ds_read_b64_tr_b16 v[90:91], v26 offset:13312
    v_cvt_pk_bf16_f32 v38, v204, v205
    v_mfma_f32_32x32x16_bf16 v[160:175], v[108:111], v[96:99], v[160:175]
    ds_read_b64_tr_b16 v[92:93], v27 offset:12288
    ds_read_b64_tr_b16 v[94:95], v27 offset:13312
    v_cvt_pk_bf16_f32 v39, v206, v207
    v_mfma_f32_32x32x16_bf16 v[176:191], v[108:111], v[100:103], v[176:191]
    buffer_store_dwordx4 v[36:39], v1, s[20:23], s51 offen offset:0 sc1
    s_waitcnt vmcnt(8) lgkmcnt(0)
    s_barrier
    v_mfma_f32_32x32x16_bf16 v[128:143], v[72:75], v[64:67], v[128:143]
    ds_read_b128 v[96:99], v20
    ds_read_b128 v[100:103], v20 offset:4096
    s_add_u32 m0, s45, 49152
    s_add_u32 s40, s42, 0
    buffer_load_dwordx4 v8, s[36:39], s40 offen offset:0 lds
    s_add_u32 s40, s42, 7168
    v_mfma_f32_32x32x16_bf16 v[144:159], v[72:75], v[68:71], v[144:159]
    ds_read_b64_tr_b16 v[104:105], v28 offset:0
    ds_read_b64_tr_b16 v[106:107], v28 offset:1024
    buffer_load_dwordx4 v9, s[36:39], s40 offen offset:1024 lds
    s_add_u32 s40, s42, 14336
    buffer_load_dwordx4 v8, s[36:39], s40 offen offset:2048 lds
    v_mfma_f32_32x32x16_bf16 v[160:175], v[76:79], v[64:67], v[160:175]
    ds_read_b64_tr_b16 v[108:109], v29 offset:0
    ds_read_b64_tr_b16 v[110:111], v29 offset:1024
    s_add_u32 s40, s42, 21504
    v_cvt_pk_bf16_f32 v40, v208, v209
    v_cvt_pk_bf16_f32 v41, v210, v211
    v_mfma_f32_32x32x16_bf16 v[176:191], v[76:79], v[68:71], v[176:191]
    v_cvt_pk_bf16_f32 v42, v212, v213
    v_cvt_pk_bf16_f32 v43, v214, v215
    buffer_store_dwordx4 v[40:43], v1, s[20:23], s52 offen offset:0 sc1
    s_waitcnt lgkmcnt(6)
    v_mfma_f32_32x32x16_bf16 v[128:143], v[88:91], v[80:83], v[128:143]
    ds_read_b128 v[64:67], v21
    ds_read_b128 v[68:71], v21 offset:4096
    buffer_load_dwordx4 v9, s[36:39], s40 offen offset:3072 lds
    s_add_u32 m0, s46, 49152
    s_add_u32 s40, s43, 31744
    buffer_load_dwordx4 v10, s[12:15], s43 offen lds
    v_mfma_f32_32x32x16_bf16 v[144:159], v[88:91], v[84:87], v[144:159]
    ds_read_b64_tr_b16 v[72:73], v28 offset:4096
    ds_read_b64_tr_b16 v[74:75], v28 offset:5120
    buffer_load_dwordx4 v10, s[12:15], s40 offen offset:1024 lds
    s_add_u32 s42, s42, 128
    s_and_b32 s42, s42, 1023
    v_mfma_f32_32x32x16_bf16 v[160:175], v[92:95], v[80:83], v[160:175]
    ds_read_b64_tr_b16 v[76:77], v29 offset:4096
    ds_read_b64_tr_b16 v[78:79], v29 offset:5120
    s_lshl_b32 s43, s42, 12
    v_cvt_pk_bf16_f32 v44, v216, v217
    v_cvt_pk_bf16_f32 v45, v218, v219
    v_mfma_f32_32x32x16_bf16 v[176:191], v[92:95], v[84:87], v[176:191]
    v_cvt_pk_bf16_f32 v46, v220, v221
    v_cvt_pk_bf16_f32 v47, v222, v223
    buffer_store_dwordx4 v[44:47], v1, s[20:23], s53 offen offset:0 sc1
    s_waitcnt lgkmcnt(6)
    v_mfma_f32_32x32x16_bf16 v[128:143], v[104:107], v[96:99], v[128:143]
    ds_read_b128 v[80:83], v22
    ds_read_b128 v[84:87], v22 offset:4096
    v_cvt_pk_bf16_f32 v48, v224, v225
    v_cvt_pk_bf16_f32 v49, v226, v227
    v_mfma_f32_32x32x16_bf16 v[144:159], v[104:107], v[100:103], v[144:159]
    ds_read_b64_tr_b16 v[88:89], v28 offset:8192
    ds_read_b64_tr_b16 v[90:91], v28 offset:9216
    v_cvt_pk_bf16_f32 v50, v228, v229
    v_mfma_f32_32x32x16_bf16 v[160:175], v[108:111], v[96:99], v[160:175]
    ds_read_b64_tr_b16 v[92:93], v29 offset:8192
    ds_read_b64_tr_b16 v[94:95], v29 offset:9216
    v_cvt_pk_bf16_f32 v51, v230, v231
    v_mfma_f32_32x32x16_bf16 v[176:191], v[108:111], v[100:103], v[176:191]
    buffer_store_dwordx4 v[48:51], v1, s[20:23], s50 offen offset:1024 sc1
    s_waitcnt lgkmcnt(6)
    v_mfma_f32_32x32x16_bf16 v[128:143], v[72:75], v[64:67], v[128:143]
    ds_read_b128 v[96:99], v23
    ds_read_b128 v[100:103], v23 offset:4096
    v_cvt_pk_bf16_f32 v52, v232, v233
    v_cvt_pk_bf16_f32 v53, v234, v235
    v_mfma_f32_32x32x16_bf16 v[144:159], v[72:75], v[68:71], v[144:159]
    ds_read_b64_tr_b16 v[104:105], v28 offset:12288
    ds_read_b64_tr_b16 v[106:107], v28 offset:13312
    v_cvt_pk_bf16_f32 v54, v236, v237
    v_mfma_f32_32x32x16_bf16 v[160:175], v[76:79], v[64:67], v[160:175]
    ds_read_b64_tr_b16 v[108:109], v29 offset:12288
    ds_read_b64_tr_b16 v[110:111], v29 offset:13312
    v_cvt_pk_bf16_f32 v55, v238, v239
    v_mfma_f32_32x32x16_bf16 v[176:191], v[76:79], v[68:71], v[176:191]
    buffer_store_dwordx4 v[52:55], v1, s[20:23], s51 offen offset:1024 sc1
    s_waitcnt vmcnt(12) lgkmcnt(0)
    s_barrier
    v_mfma_f32_32x32x16_bf16 v[128:143], v[88:91], v[80:83], v[128:143]
    ds_read_b128 v[64:67], v12
    ds_read_b128 v[68:71], v12 offset:4096
    s_add_u32 m0, s45, 98304
    s_add_u32 s40, s42, 0
    buffer_load_dwordx4 v8, s[36:39], s40 offen offset:0 lds
    s_add_u32 s40, s42, 7168
    v_mfma_f32_32x32x16_bf16 v[144:159], v[88:91], v[84:87], v[144:159]
    ds_read_b64_tr_b16 v[72:73], v24 offset:0
    ds_read_b64_tr_b16 v[74:75], v24 offset:1024
    buffer_load_dwordx4 v9, s[36:39], s40 offen offset:1024 lds
    s_add_u32 s40, s42, 14336
    buffer_load_dwordx4 v8, s[36:39], s40 offen offset:2048 lds
    v_mfma_f32_32x32x16_bf16 v[160:175], v[92:95], v[80:83], v[160:175]
    ds_read_b64_tr_b16 v[76:77], v25 offset:0
    ds_read_b64_tr_b16 v[78:79], v25 offset:1024
    s_add_u32 s40, s42, 21504
    v_cvt_pk_bf16_f32 v56, v240, v241
    v_cvt_pk_bf16_f32 v57, v242, v243
    v_mfma_f32_32x32x16_bf16 v[176:191], v[92:95], v[84:87], v[176:191]
    v_cvt_pk_bf16_f32 v58, v244, v245
    v_cvt_pk_bf16_f32 v59, v246, v247
    buffer_store_dwordx4 v[56:59], v1, s[20:23], s52 offen offset:1024 sc1
    s_waitcnt lgkmcnt(6)
    v_mfma_f32_32x32x16_bf16 v[128:143], v[104:107], v[96:99], v[128:143]
    ds_read_b128 v[80:83], v13
    ds_read_b128 v[84:87], v13 offset:4096
    buffer_load_dwordx4 v9, s[36:39], s40 offen offset:3072 lds
    s_add_u32 m0, s46, 98304
    s_add_u32 s40, s43, 31744
    buffer_load_dwordx4 v10, s[12:15], s43 offen lds
    v_mfma_f32_32x32x16_bf16 v[144:159], v[104:107], v[100:103], v[144:159]
    ds_read_b64_tr_b16 v[88:89], v24 offset:4096
    ds_read_b64_tr_b16 v[90:91], v24 offset:5120
    buffer_load_dwordx4 v10, s[12:15], s40 offen offset:1024 lds
    s_add_u32 s42, s42, 128
    s_and_b32 s42, s42, 1023
    v_mfma_f32_32x32x16_bf16 v[160:175], v[108:111], v[96:99], v[160:175]
    ds_read_b64_tr_b16 v[92:93], v25 offset:4096
    ds_read_b64_tr_b16 v[94:95], v25 offset:5120
    s_lshl_b32 s43, s42, 12
    v_cvt_pk_bf16_f32 v60, v248, v249
    v_cvt_pk_bf16_f32 v61, v250, v251
    v_mfma_f32_32x32x16_bf16 v[176:191], v[108:111], v[100:103], v[176:191]
    v_cvt_pk_bf16_f32 v62, v252, v253
    v_cvt_pk_bf16_f32 v63, v254, v255
    buffer_store_dwordx4 v[60:63], v1, s[20:23], s53 offen offset:1024 sc1
    s_waitcnt lgkmcnt(6)
    v_mfma_f32_32x32x16_bf16 v[128:143], v[72:75], v[64:67], v[128:143]
    ds_read_b128 v[96:99], v14
    ds_read_b128 v[100:103], v14 offset:4096
    v_mfma_f32_32x32x16_bf16 v[144:159], v[72:75], v[68:71], v[144:159]
    ds_read_b64_tr_b16 v[104:105], v24 offset:8192
    ds_read_b64_tr_b16 v[106:107], v24 offset:9216
    v_mfma_f32_32x32x16_bf16 v[160:175], v[76:79], v[64:67], v[160:175]
    ds_read_b64_tr_b16 v[108:109], v25 offset:8192
    ds_read_b64_tr_b16 v[110:111], v25 offset:9216
    v_mfma_f32_32x32x16_bf16 v[176:191], v[76:79], v[68:71], v[176:191]
    s_waitcnt lgkmcnt(6)
    v_mfma_f32_32x32x16_bf16 v[128:143], v[88:91], v[80:83], v[128:143]
    ds_read_b128 v[64:67], v15
    ds_read_b128 v[68:71], v15 offset:4096
    v_mfma_f32_32x32x16_bf16 v[144:159], v[88:91], v[84:87], v[144:159]
    ds_read_b64_tr_b16 v[72:73], v24 offset:12288
    ds_read_b64_tr_b16 v[74:75], v24 offset:13312
    v_mfma_f32_32x32x16_bf16 v[160:175], v[92:95], v[80:83], v[160:175]
    ds_read_b64_tr_b16 v[76:77], v25 offset:12288
    ds_read_b64_tr_b16 v[78:79], v25 offset:13312
    v_mfma_f32_32x32x16_bf16 v[176:191], v[92:95], v[84:87], v[176:191]
    s_waitcnt vmcnt(11) lgkmcnt(0)
    s_barrier
    v_mfma_f32_32x32x16_bf16 v[128:143], v[104:107], v[96:99], v[128:143]
    ds_read_b128 v[80:83], v16
    ds_read_b128 v[84:87], v16 offset:4096
    s_add_u32 m0, s45, 0
    s_add_u32 s40, s42, 0
    v_mfma_f32_32x32x16_bf16 v[144:159], v[104:107], v[100:103], v[144:159]
    ds_read_b64_tr_b16 v[88:89], v26 offset:0
    ds_read_b64_tr_b16 v[90:91], v26 offset:1024
    buffer_load_dwordx4 v8, s[36:39], s40 offen offset:0 lds
    s_add_u32 s40, s42, 7168
    v_mfma_f32_32x32x16_bf16 v[160:175], v[108:111], v[96:99], v[160:175]
    ds_read_b64_tr_b16 v[92:93], v27 offset:0
    ds_read_b64_tr_b16 v[94:95], v27 offset:1024
    buffer_load_dwordx4 v9, s[36:39], s40 offen offset:1024 lds
    s_add_u32 s40, s42, 14336
    v_mfma_f32_32x32x16_bf16 v[176:191], v[108:111], v[100:103], v[176:191]
    buffer_load_dwordx4 v8, s[36:39], s40 offen offset:2048 lds
    s_add_u32 s40, s42, 21504
    s_waitcnt lgkmcnt(6)
    v_mfma_f32_32x32x16_bf16 v[128:143], v[72:75], v[64:67], v[128:143]
    ds_read_b128 v[96:99], v17
    ds_read_b128 v[100:103], v17 offset:4096
    buffer_load_dwordx4 v9, s[36:39], s40 offen offset:3072 lds
    s_add_u32 m0, s46, 0
    v_mfma_f32_32x32x16_bf16 v[144:159], v[72:75], v[68:71], v[144:159]
    ds_read_b64_tr_b16 v[104:105], v26 offset:4096
    ds_read_b64_tr_b16 v[106:107], v26 offset:5120
    s_add_u32 s40, s43, 31744
    buffer_load_dwordx4 v10, s[12:15], s43 offen lds
    v_mfma_f32_32x32x16_bf16 v[160:175], v[76:79], v[64:67], v[160:175]
    ds_read_b64_tr_b16 v[108:109], v27 offset:4096
    ds_read_b64_tr_b16 v[110:111], v27 offset:5120
    buffer_load_dwordx4 v10, s[12:15], s40 offen offset:1024 lds
    s_add_u32 s42, s42, 128
    v_mfma_f32_32x32x16_bf16 v[176:191], v[76:79], v[68:71], v[176:191]
    s_and_b32 s42, s42, 1023
    s_lshl_b32 s43, s42, 12
    s_waitcnt lgkmcnt(6)
    v_mfma_f32_32x32x16_bf16 v[128:143], v[88:91], v[80:83], v[128:143]
    ds_read_b128 v[64:67], v18
    ds_read_b128 v[68:71], v18 offset:4096
    v_mfma_f32_32x32x16_bf16 v[144:159], v[88:91], v[84:87], v[144:159]
    ds_read_b64_tr_b16 v[72:73], v26 offset:8192
    ds_read_b64_tr_b16 v[74:75], v26 offset:9216
    v_mfma_f32_32x32x16_bf16 v[160:175], v[92:95], v[80:83], v[160:175]
    ds_read_b64_tr_b16 v[76:77], v27 offset:8192
    ds_read_b64_tr_b16 v[78:79], v27 offset:9216
    v_mfma_f32_32x32x16_bf16 v[176:191], v[92:95], v[84:87], v[176:191]
    s_waitcnt lgkmcnt(6)
    v_mfma_f32_32x32x16_bf16 v[128:143], v[104:107], v[96:99], v[128:143]
    ds_read_b128 v[80:83], v19
    ds_read_b128 v[84:87], v19 offset:4096
    v_mfma_f32_32x32x16_bf16 v[144:159], v[104:107], v[100:103], v[144:159]
    ds_read_b64_tr_b16 v[88:89], v26 offset:12288
    ds_read_b64_tr_b16 v[90:91], v26 offset:13312
    v_mfma_f32_32x32x16_bf16 v[160:175], v[108:111], v[96:99], v[160:175]
    ds_read_b64_tr_b16 v[92:93], v27 offset:12288
    ds_read_b64_tr_b16 v[94:95], v27 offset:13312
    v_mfma_f32_32x32x16_bf16 v[176:191], v[108:111], v[100:103], v[176:191]
    s_waitcnt vmcnt(0) lgkmcnt(0)
    s_barrier
    s_cmp_lg_u32 s3, 0
    s_cbranch_scc1 k1_nosig
    v_mov_b32 v3, 0
    s_mov_b32 s41, 0
k1_ip:
    buffer_load_ubyte v2, v3, s[80:83], s6 offen sc1
    s_waitcnt vmcnt(0)
    v_readfirstlane_b32 s29, v2
    s_cmp_lg_u32 s29, 0
    s_cbranch_scc1 k1_ipd
    s_sleep 8
    s_add_u32 s41, s41, 1
    s_cmp_lt_u32 s41, 0x100000
    s_cbranch_scc1 k1_ip
k1_ipd:
    s_lshl_b32 s28, s6, 8
    s_add_u32 s28, s28, s7
    s_add_u32 s28, s28, 57688064
    v_mov_b32 v2, 1
    s_mov_b64 exec, 1
    buffer_store_byte v2, v3, s[20:23], s28 offen sc1
    s_mov_b64 exec, -1
k1_nosig:
    v_mfma_f32_32x32x16_bf16 v[128:143], v[72:75], v[64:67], v[128:143]
    ds_read_b128 v[96:99], v20
    ds_read_b128 v[100:103], v20 offset:4096
    s_add_u32 m0, s45, 49152
    s_add_u32 s40, s42, 0
    v_mfma_f32_32x32x16_bf16 v[144:159], v[72:75], v[68:71], v[144:159]
    ds_read_b64_tr_b16 v[104:105], v28 offset:0
    ds_read_b64_tr_b16 v[106:107], v28 offset:1024
    buffer_load_dwordx4 v8, s[36:39], s40 offen offset:0 lds
    s_add_u32 s40, s42, 7168
    v_mfma_f32_32x32x16_bf16 v[160:175], v[76:79], v[64:67], v[160:175]
    ds_read_b64_tr_b16 v[108:109], v29 offset:0
    ds_read_b64_tr_b16 v[110:111], v29 offset:1024
    buffer_load_dwordx4 v9, s[36:39], s40 offen offset:1024 lds
    s_add_u32 s40, s42, 14336
    v_mfma_f32_32x32x16_bf16 v[176:191], v[76:79], v[68:71], v[176:191]
    buffer_load_dwordx4 v8, s[36:39], s40 offen offset:2048 lds
    s_add_u32 s40, s42, 21504
    s_waitcnt lgkmcnt(6)
    v_mfma_f32_32x32x16_bf16 v[128:143], v[88:91], v[80:83], v[128:143]
    ds_read_b128 v[64:67], v21
    ds_read_b128 v[68:71], v21 offset:4096
    buffer_load_dwordx4 v9, s[36:39], s40 offen offset:3072 lds
    s_add_u32 m0, s46, 49152
    v_mfma_f32_32x32x16_bf16 v[144:159], v[88:91], v[84:87], v[144:159]
    ds_read_b64_tr_b16 v[72:73], v28 offset:4096
    ds_read_b64_tr_b16 v[74:75], v28 offset:5120
    s_add_u32 s40, s43, 31744
    buffer_load_dwordx4 v10, s[12:15], s43 offen lds
    v_mfma_f32_32x32x16_bf16 v[160:175], v[92:95], v[80:83], v[160:175]
    ds_read_b64_tr_b16 v[76:77], v29 offset:4096
    ds_read_b64_tr_b16 v[78:79], v29 offset:5120
    buffer_load_dwordx4 v10, s[12:15], s40 offen offset:1024 lds
    s_add_u32 s42, s42, 128
    v_mfma_f32_32x32x16_bf16 v[176:191], v[92:95], v[84:87], v[176:191]
    s_and_b32 s42, s42, 1023
    s_lshl_b32 s43, s42, 12
    s_waitcnt lgkmcnt(6)
    v_mfma_f32_32x32x16_bf16 v[128:143], v[104:107], v[96:99], v[128:143]
    ds_read_b128 v[80:83], v22
    ds_read_b128 v[84:87], v22 offset:4096
    v_mfma_f32_32x32x16_bf16 v[144:159], v[104:107], v[100:103], v[144:159]
    ds_read_b64_tr_b16 v[88:89], v28 offset:8192
    ds_read_b64_tr_b16 v[90:91], v28 offset:9216
    v_mfma_f32_32x32x16_bf16 v[160:175], v[108:111], v[96:99], v[160:175]
    ds_read_b64_tr_b16 v[92:93], v29 offset:8192
    ds_read_b64_tr_b16 v[94:95], v29 offset:9216
    v_mfma_f32_32x32x16_bf16 v[176:191], v[108:111], v[100:103], v[176:191]
    s_waitcnt lgkmcnt(6)
    v_mfma_f32_32x32x16_bf16 v[128:143], v[72:75], v[64:67], v[128:143]
    ds_read_b128 v[96:99], v23
    ds_read_b128 v[100:103], v23 offset:4096
    v_mfma_f32_32x32x16_bf16 v[144:159], v[72:75], v[68:71], v[144:159]
    ds_read_b64_tr_b16 v[104:105], v28 offset:12288
    ds_read_b64_tr_b16 v[106:107], v28 offset:13312
    v_mfma_f32_32x32x16_bf16 v[160:175], v[76:79], v[64:67], v[160:175]
    ds_read_b64_tr_b16 v[108:109], v29 offset:12288
    ds_read_b64_tr_b16 v[110:111], v29 offset:13312
    v_mfma_f32_32x32x16_bf16 v[176:191], v[76:79], v[68:71], v[176:191]
    s_waitcnt lgkmcnt(0)
    s_barrier
    v_mfma_f32_32x32x16_bf16 v[128:143], v[88:91], v[80:83], v[128:143]
    ds_read_b128 v[64:67], v12
    ds_read_b128 v[68:71], v12 offset:4096
    s_add_u32 m0, s45, 98304
    s_add_u32 s40, s42, 0
    v_mfma_f32_32x32x16_bf16 v[144:159], v[88:91], v[84:87], v[144:159]
    ds_read_b64_tr_b16 v[72:73], v24 offset:0
    ds_read_b64_tr_b16 v[74:75], v24 offset:1024
    buffer_load_dwordx4 v8, s[36:39], s40 offen offset:0 lds
    s_add_u32 s40, s42, 7168
    v_mfma_f32_32x32x16_bf16 v[160:175], v[92:95], v[80:83], v[160:175]
    ds_read_b64_tr_b16 v[76:77], v25 offset:0
    ds_read_b64_tr_b16 v[78:79], v25 offset:1024
    buffer_load_dwordx4 v9, s[36:39], s40 offen offset:1024 lds
    s_add_u32 s40, s42, 14336
    v_mfma_f32_32x32x16_bf16 v[176:191], v[92:95], v[84:87], v[176:191]
    buffer_load_dwordx4 v8, s[36:39], s40 offen offset:2048 lds
    s_add_u32 s40, s42, 21504
    s_waitcnt lgkmcnt(6)
    v_mfma_f32_32x32x16_bf16 v[128:143], v[104:107], v[96:99], v[128:143]
    ds_read_b128 v[80:83], v13
    ds_read_b128 v[84:87], v13 offset:4096
    buffer_load_dwordx4 v9, s[36:39], s40 offen offset:3072 lds
    s_add_u32 m0, s46, 98304
    v_mfma_f32_32x32x16_bf16 v[144:159], v[104:107], v[100:103], v[144:159]
    ds_read_b64_tr_b16 v[88:89], v24 offset:4096
    ds_read_b64_tr_b16 v[90:91], v24 offset:5120
    s_add_u32 s40, s43, 31744
    buffer_load_dwordx4 v10, s[12:15], s43 offen lds
    v_mfma_f32_32x32x16_bf16 v[160:175], v[108:111], v[96:99], v[160:175]
    ds_read_b64_tr_b16 v[92:93], v25 offset:4096
    ds_read_b64_tr_b16 v[94:95], v25 offset:5120
    buffer_load_dwordx4 v10, s[12:15], s40 offen offset:1024 lds
    s_add_u32 s42, s42, 128
    v_mfma_f32_32x32x16_bf16 v[176:191], v[108:111], v[100:103], v[176:191]
    s_and_b32 s42, s42, 1023
    s_lshl_b32 s43, s42, 12
    s_waitcnt lgkmcnt(6)
    v_mfma_f32_32x32x16_bf16 v[128:143], v[72:75], v[64:67], v[128:143]
    ds_read_b128 v[96:99], v14
    ds_read_b128 v[100:103], v14 offset:4096
    v_mfma_f32_32x32x16_bf16 v[144:159], v[72:75], v[68:71], v[144:159]
    ds_read_b64_tr_b16 v[104:105], v24 offset:8192
    ds_read_b64_tr_b16 v[106:107], v24 offset:9216
    v_mfma_f32_32x32x16_bf16 v[160:175], v[76:79], v[64:67], v[160:175]
    ds_read_b64_tr_b16 v[108:109], v25 offset:8192
    ds_read_b64_tr_b16 v[110:111], v25 offset:9216
    v_mfma_f32_32x32x16_bf16 v[176:191], v[76:79], v[68:71], v[176:191]
    s_waitcnt lgkmcnt(6)
    v_mfma_f32_32x32x16_bf16 v[128:143], v[88:91], v[80:83], v[128:143]
    ds_read_b128 v[64:67], v15
    ds_read_b128 v[68:71], v15 offset:4096
    v_mfma_f32_32x32x16_bf16 v[144:159], v[88:91], v[84:87], v[144:159]
    ds_read_b64_tr_b16 v[72:73], v24 offset:12288
    ds_read_b64_tr_b16 v[74:75], v24 offset:13312
    v_mfma_f32_32x32x16_bf16 v[160:175], v[92:95], v[80:83], v[160:175]
    ds_read_b64_tr_b16 v[76:77], v25 offset:12288
    ds_read_b64_tr_b16 v[78:79], v25 offset:13312
    v_mfma_f32_32x32x16_bf16 v[176:191], v[92:95], v[84:87], v[176:191]
    s_waitcnt vmcnt(6) lgkmcnt(0)
    s_barrier
    s_cmp_lg_u32 s3, 7
    s_cbranch_scc1 k1_d21
    s_mov_b32 s46, 0
    s_mov_b32 s60, 0
    s_mov_b32 s61, 0
    s_sub_u32 s47, 15, s7
    s_cmp_eq_u32 s46, 0
    s_cselect_b32 s47, s47, s7
    s_lshl_b32 s50, s47, 2
    s_add_u32 s50, s50, 4
    s_mov_b32 s52, 0
    s_mov_b32 s53, 0
    s_lshr_b32 s28, s52, 13
    s_add_u32 s28, s28, 4
    s_lshr_b32 s28, s28, 3
    s_min_u32 s28, s28, 7
    s_lshl_b32 s29, 2, s28
    s_sub_u32 s29, s29, 1
    s_and_b32 s28, s61, s29
    s_cmp_eq_u32 s28, s29
    s_cbranch_scc1 l_rbok_1
    s_lshl_b32 s40, s6, 8
    s_add_u32 s40, s40, 57688064
    v_mov_b32 v4, 0
    s_mov_b32 s41, 0
l_rbpoll_2:
    buffer_load_dwordx2 v[2:3], v4, s[20:23], s40 offen sc1
    s_waitcnt vmcnt(0)
    v_readfirstlane_b32 s61, v2
    v_readfirstlane_b32 s28, v3
    s_mul_i32 s61, s61, 0x01020408
    s_lshr_b32 s61, s61, 24
    s_and_b32 s61, s61, 15
    s_mul_i32 s28, s28, 0x01020408
    s_lshr_b32 s28, s28, 20
    s_and_b32 s28, s28, 0xf0
    s_or_b32 s61, s61, s28
    s_and_b32 s28, s61, s29
    s_cmp_eq_u32 s28, s29
    s_cbranch_scc1 l_rbgot_3
    s_sleep 4
    s_add_u32 s41, s41, 1
    s_cmp_lt_u32 s41, 0x100000
    s_cbranch_scc1 l_rbpoll_2
l_rbgot_3:
l_rbok_1:
    s_add_u32 m0, s53, 0
    s_add_u32 s28, s52, 0
    buffer_load_dwordx4 v1, s[84:87], s28 offen offset:0 sc1 lds
    buffer_load_dwordx4 v1, s[84:87], s28 offen offset:1024 sc1 lds
    buffer_load_dwordx4 v1, s[84:87], s28 offen offset:2048 sc1 lds
    buffer_load_dwordx4 v1, s[84:87], s28 offen offset:3072 sc1 lds
    s_add_u32 m0, s53, 4096
    s_add_u32 s28, s52, 4096
    buffer_load_dwordx4 v1, s[84:87], s28 offen offset:0 sc1 lds
    buffer_load_dwordx4 v1, s[84:87], s28 offen offset:1024 sc1 lds
    buffer_load_dwordx4 v1, s[84:87], s28 offen offset:2048 sc1 lds
    buffer_load_dwordx4 v1, s[84:87], s28 offen offset:3072 sc1 lds
    s_add_u32 m0, s53, 8192
    s_add_u32 s28, s52, 0
    buffer_load_dwordx4 v1, s[32:35], s28 offen offset:0 sc1 lds
    buffer_load_dwordx4 v1, s[32:35], s28 offen offset:1024 sc1 lds
    buffer_load_dwordx4 v1, s[32:35], s28 offen offset:2048 sc1 lds
    buffer_load_dwordx4 v1, s[32:35], s28 offen offset:3072 sc1 lds
    s_add_u32 m0, s53, 12288
    s_add_u32 s28, s52, 4096
    buffer_load_dwordx4 v1, s[32:35], s28 offen offset:0 sc1 lds
    buffer_load_dwordx4 v1, s[32:35], s28 offen offset:1024 sc1 lds
    buffer_load_dwordx4 v1, s[32:35], s28 offen offset:2048 sc1 lds
    buffer_load_dwordx4 v1, s[32:35], s28 offen offset:3072 sc1 lds
    s_add_u32 s52, s52, 8192
    s_add_u32 s53, s53, 16384
    s_cmp_ge_u32 s53, 147456
    s_cselect_b32 s53, 0, s53
    s_add_u32 m0, s53, 0
    s_add_u32 s28, s52, 0
    buffer_load_dwordx4 v1, s[84:87], s28 offen offset:0 sc1 lds
    buffer_load_dwordx4 v1, s[84:87], s28 offen offset:1024 sc1 lds
    buffer_load_dwordx4 v1, s[84:87], s28 offen offset:2048 sc1 lds
    buffer_load_dwordx4 v1, s[84:87], s28 offen offset:3072 sc1 lds
    s_add_u32 m0, s53, 4096
    s_add_u32 s28, s52, 4096
    buffer_load_dwordx4 v1, s[84:87], s28 offen offset:0 sc1 lds
    buffer_load_dwordx4 v1, s[84:87], s28 offen offset:1024 sc1 lds
    buffer_load_dwordx4 v1, s[84:87], s28 offen offset:2048 sc1 lds
    buffer_load_dwordx4 v1, s[84:87], s28 offen offset:3072 sc1 lds
    s_add_u32 m0, s53, 8192
    s_add_u32 s28, s52, 0
    buffer_load_dwordx4 v1, s[32:35], s28 offen offset:0 sc1 lds
    buffer_load_dwordx4 v1, s[32:35], s28 offen offset:1024 sc1 lds
    buffer_load_dwordx4 v1, s[32:35], s28 offen offset:2048 sc1 lds
    buffer_load_dwordx4 v1, s[32:35], s28 offen offset:3072 sc1 lds
    s_add_u32 m0, s53, 12288
    s_add_u32 s28, s52, 4096
    buffer_load_dwordx4 v1, s[32:35], s28 offen offset:0 sc1 lds
    buffer_load_dwordx4 v1, s[32:35], s28 offen offset:1024 sc1 lds
    buffer_load_dwordx4 v1, s[32:35], s28 offen offset:2048 sc1 lds
    buffer_load_dwordx4 v1, s[32:35], s28 offen offset:3072 sc1 lds
    s_add_u32 s52, s52, 8192
    s_add_u32 s53, s53, 16384
    s_cmp_ge_u32 s53, 147456
    s_cselect_b32 s53, 0, s53
    s_add_u32 m0, s53, 0
    s_add_u32 s28, s52, 0
    buffer_load_dwordx4 v1, s[84:87], s28 offen offset:0 sc1 lds
    buffer_load_dwordx4 v1, s[84:87], s28 offen offset:1024 sc1 lds
    buffer_load_dwordx4 v1, s[84:87], s28 offen offset:2048 sc1 lds
    buffer_load_dwordx4 v1, s[84:87], s28 offen offset:3072 sc1 lds
    s_add_u32 m0, s53, 4096
    s_add_u32 s28, s52, 4096
    buffer_load_dwordx4 v1, s[84:87], s28 offen offset:0 sc1 lds
    buffer_load_dwordx4 v1, s[84:87], s28 offen offset:1024 sc1 lds
    buffer_load_dwordx4 v1, s[84:87], s28 offen offset:2048 sc1 lds
    buffer_load_dwordx4 v1, s[84:87], s28 offen offset:3072 sc1 lds
    s_add_u32 m0, s53, 8192
    s_add_u32 s28, s52, 0
    buffer_load_dwordx4 v1, s[32:35], s28 offen offset:0 sc1 lds
    buffer_load_dwordx4 v1, s[32:35], s28 offen offset:1024 sc1 lds
    buffer_load_dwordx4 v1, s[32:35], s28 offen offset:2048 sc1 lds
    buffer_load_dwordx4 v1, s[32:35], s28 offen offset:3072 sc1 lds
    s_add_u32 m0, s53, 12288
    s_add_u32 s28, s52, 4096
    buffer_load_dwordx4 v1, s[32:35], s28 offen offset:0 sc1 lds
    buffer_load_dwordx4 v1, s[32:35], s28 offen offset:1024 sc1 lds
    buffer_load_dwordx4 v1, s[32:35], s28 offen offset:2048 sc1 lds
    buffer_load_dwordx4 v1, s[32:35], s28 offen offset:3072 sc1 lds
    s_add_u32 s52, s52, 8192
    s_add_u32 s53, s53, 16384
    s_cmp_ge_u32 s53, 147456
    s_cselect_b32 s53, 0, s53
k1_d21:
    v_mfma_f32_32x32x16_bf16 v[128:143], v[104:107], v[96:99], v[128:143]
    ds_read_b128 v[80:83], v16
    ds_read_b128 v[84:87], v16 offset:4096
    v_mfma_f32_32x32x16_bf16 v[144:159], v[104:107], v[100:103], v[144:159]
    ds_read_b64_tr_b16 v[88:89], v26 offset:0
    ds_read_b64_tr_b16 v[90:91], v26 offset:1024
    v_mfma_f32_32x32x16_bf16 v[160:175], v[108:111], v[96:99], v[160:175]
    ds_read_b64_tr_b16 v[92:93], v27 offset:0
    ds_read_b64_tr_b16 v[94:95], v27 offset:1024
    v_mfma_f32_32x32x16_bf16 v[176:191], v[108:111], v[100:103], v[176:191]
    s_waitcnt lgkmcnt(6)
    v_mfma_f32_32x32x16_bf16 v[128:143], v[72:75], v[64:67], v[128:143]
    ds_read_b128 v[96:99], v17
    ds_read_b128 v[100:103], v17 offset:4096
    v_mfma_f32_32x32x16_bf16 v[144:159], v[72:75], v[68:71], v[144:159]
    ds_read_b64_tr_b16 v[104:105], v26 offset:4096
    ds_read_b64_tr_b16 v[106:107], v26 offset:5120
    v_mfma_f32_32x32x16_bf16 v[160:175], v[76:79], v[64:67], v[160:175]
    ds_read_b64_tr_b16 v[108:109], v27 offset:4096
    ds_read_b64_tr_b16 v[110:111], v27 offset:5120
    v_mfma_f32_32x32x16_bf16 v[176:191], v[76:79], v[68:71], v[176:191]
    s_waitcnt lgkmcnt(6)
    v_mfma_f32_32x32x16_bf16 v[128:143], v[88:91], v[80:83], v[128:143]
    ds_read_b128 v[64:67], v18
    ds_read_b128 v[68:71], v18 offset:4096
    v_mfma_f32_32x32x16_bf16 v[144:159], v[88:91], v[84:87], v[144:159]
    ds_read_b64_tr_b16 v[72:73], v26 offset:8192
    ds_read_b64_tr_b16 v[74:75], v26 offset:9216
    v_mfma_f32_32x32x16_bf16 v[160:175], v[92:95], v[80:83], v[160:175]
    ds_read_b64_tr_b16 v[76:77], v27 offset:8192
    ds_read_b64_tr_b16 v[78:79], v27 offset:9216
    v_mfma_f32_32x32x16_bf16 v[176:191], v[92:95], v[84:87], v[176:191]
    s_waitcnt lgkmcnt(6)
    v_mfma_f32_32x32x16_bf16 v[128:143], v[104:107], v[96:99], v[128:143]
    ds_read_b128 v[80:83], v19
    ds_read_b128 v[84:87], v19 offset:4096
    v_mfma_f32_32x32x16_bf16 v[144:159], v[104:107], v[100:103], v[144:159]
    ds_read_b64_tr_b16 v[88:89], v26 offset:12288
    ds_read_b64_tr_b16 v[90:91], v26 offset:13312
    v_mfma_f32_32x32x16_bf16 v[160:175], v[108:111], v[96:99], v[160:175]
    ds_read_b64_tr_b16 v[92:93], v27 offset:12288
    ds_read_b64_tr_b16 v[94:95], v27 offset:13312
    v_mfma_f32_32x32x16_bf16 v[176:191], v[108:111], v[100:103], v[176:191]
    s_cmp_eq_u32 s3, 7
    s_cbranch_scc1 k1_w22
    s_waitcnt vmcnt(0)
k1_w22:
    s_waitcnt lgkmcnt(0)
    s_barrier
    s_cmp_lg_u32 s3, 7
    s_cbranch_scc1 k1_d22
    s_add_u32 m0, s53, 0
    s_add_u32 s28, s52, 0
    buffer_load_dwordx4 v1, s[84:87], s28 offen offset:0 sc1 lds
    buffer_load_dwordx4 v1, s[84:87], s28 offen offset:1024 sc1 lds
    buffer_load_dwordx4 v1, s[84:87], s28 offen offset:2048 sc1 lds
    buffer_load_dwordx4 v1, s[84:87], s28 offen offset:3072 sc1 lds
    s_add_u32 m0, s53, 4096
    s_add_u32 s28, s52, 4096
    buffer_load_dwordx4 v1, s[84:87], s28 offen offset:0 sc1 lds
    buffer_load_dwordx4 v1, s[84:87], s28 offen offset:1024 sc1 lds
    buffer_load_dwordx4 v1, s[84:87], s28 offen offset:2048 sc1 lds
    buffer_load_dwordx4 v1, s[84:87], s28 offen offset:3072 sc1 lds
    s_add_u32 m0, s53, 8192
    s_add_u32 s28, s52, 0
    buffer_load_dwordx4 v1, s[32:35], s28 offen offset:0 sc1 lds
    buffer_load_dwordx4 v1, s[32:35], s28 offen offset:1024 sc1 lds
    buffer_load_dwordx4 v1, s[32:35], s28 offen offset:2048 sc1 lds
    buffer_load_dwordx4 v1, s[32:35], s28 offen offset:3072 sc1 lds
    s_add_u32 m0, s53, 12288
    s_add_u32 s28, s52, 4096
    buffer_load_dwordx4 v1, s[32:35], s28 offen offset:0 sc1 lds
    buffer_load_dwordx4 v1, s[32:35], s28 offen offset:1024 sc1 lds
    buffer_load_dwordx4 v1, s[32:35], s28 offen offset:2048 sc1 lds
    buffer_load_dwordx4 v1, s[32:35], s28 offen offset:3072 sc1 lds
    s_add_u32 s52, s52, 8192
    s_add_u32 s53, s53, 16384
    s_cmp_ge_u32 s53, 147456
    s_cselect_b32 s53, 0, s53
    s_add_u32 m0, s53, 0
    s_add_u32 s28, s52, 0
    buffer_load_dwordx4 v1, s[84:87], s28 offen offset:0 sc1 lds
    buffer_load_dwordx4 v1, s[84:87], s28 offen offset:1024 sc1 lds
    buffer_load_dwordx4 v1, s[84:87], s28 offen offset:2048 sc1 lds
    buffer_load_dwordx4 v1, s[84:87], s28 offen offset:3072 sc1 lds
    s_add_u32 m0, s53, 4096
    s_add_u32 s28, s52, 4096
    buffer_load_dwordx4 v1, s[84:87], s28 offen offset:0 sc1 lds
    buffer_load_dwordx4 v1, s[84:87], s28 offen offset:1024 sc1 lds
    buffer_load_dwordx4 v1, s[84:87], s28 offen offset:2048 sc1 lds
    buffer_load_dwordx4 v1, s[84:87], s28 offen offset:3072 sc1 lds
    s_add_u32 m0, s53, 8192
    s_add_u32 s28, s52, 0
    buffer_load_dwordx4 v1, s[32:35], s28 offen offset:0 sc1 lds
    buffer_load_dwordx4 v1, s[32:35], s28 offen offset:1024 sc1 lds
    buffer_load_dwordx4 v1, s[32:35], s28 offen offset:2048 sc1 lds
    buffer_load_dwordx4 v1, s[32:35], s28 offen offset:3072 sc1 lds
    s_add_u32 m0, s53, 12288
    s_add_u32 s28, s52, 4096
    buffer_load_dwordx4 v1, s[32:35], s28 offen offset:0 sc1 lds
    buffer_load_dwordx4 v1, s[32:35], s28 offen offset:1024 sc1 lds
    buffer_load_dwordx4 v1, s[32:35], s28 offen offset:2048 sc1 lds
    buffer_load_dwordx4 v1, s[32:35], s28 offen offset:3072 sc1 lds
    s_add_u32 s52, s52, 8192
    s_add_u32 s53, s53, 16384
    s_cmp_ge_u32 s53, 147456
    s_cselect_b32 s53, 0, s53
k1_d22:
    v_mfma_f32_32x32x16_bf16 v[128:143], v[72:75], v[64:67], v[128:143]
    ds_read_b128 v[96:99], v20
    ds_read_b128 v[100:103], v20 offset:4096
    v_mfma_f32_32x32x16_bf16 v[144:159], v[72:75], v[68:71], v[144:159]
    ds_read_b64_tr_b16 v[104:105], v28 offset:0
    ds_read_b64_tr_b16 v[106:107], v28 offset:1024
    v_mfma_f32_32x32x16_bf16 v[160:175], v[76:79], v[64:67], v[160:175]
    ds_read_b64_tr_b16 v[108:109], v29 offset:0
    ds_read_b64_tr_b16 v[110:111], v29 offset:1024
    v_mfma_f32_32x32x16_bf16 v[176:191], v[76:79], v[68:71], v[176:191]
    s_waitcnt lgkmcnt(6)
    v_mfma_f32_32x32x16_bf16 v[128:143], v[88:91], v[80:83], v[128:143]
    ds_read_b128 v[64:67], v21
    ds_read_b128 v[68:71], v21 offset:4096
    v_mfma_f32_32x32x16_bf16 v[144:159], v[88:91], v[84:87], v[144:159]
    ds_read_b64_tr_b16 v[72:73], v28 offset:4096
    ds_read_b64_tr_b16 v[74:75], v28 offset:5120
    v_mfma_f32_32x32x16_bf16 v[160:175], v[92:95], v[80:83], v[160:175]
    ds_read_b64_tr_b16 v[76:77], v29 offset:4096
    ds_read_b64_tr_b16 v[78:79], v29 offset:5120
    v_mfma_f32_32x32x16_bf16 v[176:191], v[92:95], v[84:87], v[176:191]
    s_waitcnt lgkmcnt(6)
    v_mfma_f32_32x32x16_bf16 v[128:143], v[104:107], v[96:99], v[128:143]
    ds_read_b128 v[80:83], v22
    ds_read_b128 v[84:87], v22 offset:4096
    v_mfma_f32_32x32x16_bf16 v[144:159], v[104:107], v[100:103], v[144:159]
    ds_read_b64_tr_b16 v[88:89], v28 offset:8192
    ds_read_b64_tr_b16 v[90:91], v28 offset:9216
    v_mfma_f32_32x32x16_bf16 v[160:175], v[108:111], v[96:99], v[160:175]
    ds_read_b64_tr_b16 v[92:93], v29 offset:8192
    ds_read_b64_tr_b16 v[94:95], v29 offset:9216
    v_mfma_f32_32x32x16_bf16 v[176:191], v[108:111], v[100:103], v[176:191]
    s_waitcnt lgkmcnt(6)
    v_mfma_f32_32x32x16_bf16 v[128:143], v[72:75], v[64:67], v[128:143]
    ds_read_b128 v[96:99], v23
    ds_read_b128 v[100:103], v23 offset:4096
    v_mfma_f32_32x32x16_bf16 v[144:159], v[72:75], v[68:71], v[144:159]
    ds_read_b64_tr_b16 v[104:105], v28 offset:12288
    ds_read_b64_tr_b16 v[106:107], v28 offset:13312
    v_mfma_f32_32x32x16_bf16 v[160:175], v[76:79], v[64:67], v[160:175]
    ds_read_b64_tr_b16 v[108:109], v29 offset:12288
    ds_read_b64_tr_b16 v[110:111], v29 offset:13312
    v_mfma_f32_32x32x16_bf16 v[176:191], v[76:79], v[68:71], v[176:191]
    s_waitcnt lgkmcnt(6)
    v_mfma_f32_32x32x16_bf16 v[128:143], v[88:91], v[80:83], v[128:143]
    v_mfma_f32_32x32x16_bf16 v[144:159], v[88:91], v[84:87], v[144:159]
    v_mfma_f32_32x32x16_bf16 v[160:175], v[92:95], v[80:83], v[160:175]
    v_mfma_f32_32x32x16_bf16 v[176:191], v[92:95], v[84:87], v[176:191]
    s_waitcnt lgkmcnt(0)
    v_mfma_f32_32x32x16_bf16 v[128:143], v[104:107], v[96:99], v[128:143]
    v_mfma_f32_32x32x16_bf16 v[144:159], v[104:107], v[100:103], v[144:159]
    v_mfma_f32_32x32x16_bf16 v[160:175], v[108:111], v[96:99], v[160:175]
    v_mfma_f32_32x32x16_bf16 v[176:191], v[108:111], v[100:103], v[176:191]
    s_barrier
    s_mov_b32 s28, 0x3e0293ee
    s_lshr_b32 s29, s3, 1
    s_lshl_b32 s29, s29, 14
    s_and_b32 s40, s3, 1
    s_lshl_b32 s40, s40, 12
    s_add_u32 s29, s29, s40
    s_add_u32 s29, s29, 81920
    v_add_u32 v2, s29, v1
    s_nop 7
    v_mul_f32 v128, s28, v128
    v_mul_f32 v129, s28, v129
    v_mul_f32 v130, s28, v130
    v_mul_f32 v131, s28, v131
    v_mul_f32 v132, s28, v132
    v_mul_f32 v133, s28, v133
    v_mul_f32 v134, s28, v134
    v_mul_f32 v135, s28, v135
    v_mul_f32 v136, s28, v136
    v_mul_f32 v137, s28, v137
    v_mul_f32 v138, s28, v138
    v_mul_f32 v139, s28, v139
    v_mul_f32 v140, s28, v140
    v_mul_f32 v141, s28, v141
    v_mul_f32 v142, s28, v142
    v_mul_f32 v143, s28, v143
    v_mul_f32 v144, s28, v144
    v_mul_f32 v145, s28, v145
    v_mul_f32 v146, s28, v146
    v_mul_f32 v147, s28, v147
    v_mul_f32 v148, s28, v148
    v_mul_f32 v149, s28, v149
    v_mul_f32 v150, s28, v150
    v_mul_f32 v151, s28, v151
    v_mul_f32 v152, s28, v152
    v_mul_f32 v153, s28, v153
    v_mul_f32 v154, s28, v154
    v_mul_f32 v155, s28, v155
    v_mul_f32 v156, s28, v156
    v_mul_f32 v157, s28, v157
    v_mul_f32 v158, s28, v158
    v_mul_f32 v159, s28, v159
    v_mul_f32 v160, s28, v160
    v_mul_f32 v161, s28, v161
    v_mul_f32 v162, s28, v162
    v_mul_f32 v163, s28, v163
    v_mul_f32 v164, s28, v164
    v_mul_f32 v165, s28, v165
    v_mul_f32 v166, s28, v166
    v_mul_f32 v167, s28, v167
    v_mul_f32 v168, s28, v168
    v_mul_f32 v169, s28, v169
    v_mul_f32 v170, s28, v170
    v_mul_f32 v171, s28, v171
    v_mul_f32 v172, s28, v172
    v_mul_f32 v173, s28, v173
    v_mul_f32 v174, s28, v174
    v_mul_f32 v175, s28, v175
    v_mul_f32 v176, s28, v176
    v_mul_f32 v177, s28, v177
    v_mul_f32 v178, s28, v178
    v_mul_f32 v179, s28, v179
    v_mul_f32 v180, s28, v180
    v_mul_f32 v181, s28, v181
    v_mul_f32 v182, s28, v182
    v_mul_f32 v183, s28, v183
    v_mul_f32 v184, s28, v184
    v_mul_f32 v185, s28, v185
    v_mul_f32 v186, s28, v186
    v_mul_f32 v187, s28, v187
    v_mul_f32 v188, s28, v188
    v_mul_f32 v189, s28, v189
    v_mul_f32 v190, s28, v190
    v_mul_f32 v191, s28, v191
    v_cvt_pk_bf16_f32 v32, v128, v129
    v_cvt_pk_bf16_f32 v33, v130, v131
    v_cvt_pk_bf16_f32 v34, v132, v133
    v_cvt_pk_bf16_f32 v35, v134, v135
    ds_write_b128 v2, v[32:35] offset:0
    v_cvt_pk_bf16_f32 v36, v136, v137
    v_cvt_pk_bf16_f32 v37, v138, v139
    v_cvt_pk_bf16_f32 v38, v140, v141
    v_cvt_pk_bf16_f32 v39, v142, v143
    ds_write_b128 v2, v[36:39] offset:1024
    v_cvt_pk_bf16_f32 v40, v144, v145
    v_cvt_pk_bf16_f32 v41, v146, v147
    v_cvt_pk_bf16_f32 v42, v148, v149
    v_cvt_pk_bf16_f32 v43, v150, v151
    ds_write_b128 v2, v[40:43] offset:8192
    v_cvt_pk_bf16_f32 v44, v152, v153
    v_cvt_pk_bf16_f32 v45, v154, v155
    v_cvt_pk_bf16_f32 v46, v156, v157
    v_cvt_pk_bf16_f32 v47, v158, v159
    ds_write_b128 v2, v[44:47] offset:9216
    v_cvt_pk_bf16_f32 v48, v160, v161
    v_cvt_pk_bf16_f32 v49, v162, v163
    v_cvt_pk_bf16_f32 v50, v164, v165
    v_cvt_pk_bf16_f32 v51, v166, v167
    ds_write_b128 v2, v[48:51] offset:2048
    v_cvt_pk_bf16_f32 v52, v168, v169
    v_cvt_pk_bf16_f32 v53, v170, v171
    v_cvt_pk_bf16_f32 v54, v172, v173
    v_cvt_pk_bf16_f32 v55, v174, v175
    ds_write_b128 v2, v[52:55] offset:3072
    v_cvt_pk_bf16_f32 v56, v176, v177
    v_cvt_pk_bf16_f32 v57, v178, v179
    v_cvt_pk_bf16_f32 v58, v180, v181
    v_cvt_pk_bf16_f32 v59, v182, v183
    ds_write_b128 v2, v[56:59] offset:10240
    v_cvt_pk_bf16_f32 v60, v184, v185
    v_cvt_pk_bf16_f32 v61, v186, v187
    v_cvt_pk_bf16_f32 v62, v188, v189
    v_cvt_pk_bf16_f32 v63, v190, v191
    ds_write_b128 v2, v[60:63] offset:11264
    s_waitcnt lgkmcnt(0)
    s_barrier
    s_cmp_eq_u32 s3, 7
    s_cbranch_scc1 l_task
    s_cmp_ge_u32 s3, 4
    s_cbranch_scc1 k1_side
    s_lshl_b32 s28, s3, 13
    s_add_u32 s28, s28, 81920
    v_add_u32 v2, s28, v1
    v_and_b32 v3, 31, v0
    v_lshrrev_b32 v4, 5, v0
    v_lshlrev_b32 v18, 2, v4
    v_sub_u32 v18, v3, v18
    s_mov_b32 s46, 0
    s_mov_b32 s60, 0
    s_mov_b32 s61, 0
    ds_read_b128 v[160:163], v2 offset:0
    ds_read_b128 v[164:167], v2 offset:1024
    ds_read_b128 v[168:171], v2 offset:2048
    ds_read_b128 v[172:175], v2 offset:3072
    ds_read_b128 v[176:179], v2 offset:4096
    ds_read_b128 v[180:183], v2 offset:5120
    ds_read_b128 v[184:187], v2 offset:6144
    ds_read_b128 v[188:191], v2 offset:7168
    ds_read_b128 v[64:67], v2 offset:32768
    ds_read_b128 v[68:71], v2 offset:33792
    ds_read_b128 v[72:75], v2 offset:34816
    ds_read_b128 v[76:79], v2 offset:35840
    ds_read_b128 v[80:83], v2 offset:36864
    ds_read_b128 v[84:87], v2 offset:37888
    ds_read_b128 v[88:91], v2 offset:38912
    ds_read_b128 v[92:95], v2 offset:39936
    s_sub_u32 s47, 15, s7
    s_cmp_eq_u32 s46, 0
    s_cselect_b32 s47, s47, s7
    s_lshl_b32 s50, s47, 2
    s_add_u32 s50, s50, 4
    s_waitcnt lgkmcnt(0)
b_task:
    s_lshl_b32 s28, s47, 7
    s_lshl_b32 s29, s3, 5
    s_add_u32 s48, s28, s29
    s_sub_u32 s49, s50, 3
    s_add_u32 s49, s49, s3
    v_mov_b32 v192, 0
    v_mov_b32 v193, 0
    v_mov_b32 v194, 0
    v_mov_b32 v195, 0
    v_mov_b32 v196, 0
    v_mov_b32 v197, 0
    v_mov_b32 v198, 0
    v_mov_b32 v199, 0
    v_mov_b32 v200, 0
    v_mov_b32 v201, 0
    v_mov_b32 v202, 0
    v_mov_b32 v203, 0
    v_mov_b32 v204, 0
    v_mov_b32 v205, 0
    v_mov_b32 v206, 0
    v_mov_b32 v207, 0
    v_mov_b32 v208, 0
    v_mov_b32 v209, 0
    v_mov_b32 v210, 0
    v_mov_b32 v211, 0
    v_mov_b32 v212, 0
    v_mov_b32 v213, 0
    v_mov_b32 v214, 0
    v_mov_b32 v215, 0
    v_mov_b32 v216, 0
    v_mov_b32 v217, 0
    v_mov_b32 v218, 0
    v_mov_b32 v219, 0
    v_mov_b32 v220, 0
    v_mov_b32 v221, 0
    v_mov_b32 v222, 0
    v_mov_b32 v223, 0
    v_mov_b32 v224, 0
    v_mov_b32 v225, 0
    v_mov_b32 v226, 0
    v_mov_b32 v227, 0
    v_mov_b32 v228, 0
    v_mov_b32 v229, 0
    v_mov_b32 v230, 0
    v_mov_b32 v231, 0
    v_mov_b32 v232, 0
    v_mov_b32 v233, 0
    v_mov_b32 v234, 0
    v_mov_b32 v235, 0
    v_mov_b32 v236, 0
    v_mov_b32 v237, 0
    v_mov_b32 v238, 0
    v_mov_b32 v239, 0
    v_mov_b32 v240, 0
    v_mov_b32 v241, 0
    v_mov_b32 v242, 0
    v_mov_b32 v243, 0
    v_mov_b32 v244, 0
    v_mov_b32 v245, 0
    v_mov_b32 v246, 0
    v_mov_b32 v247, 0
    v_mov_b32 v248, 0
    v_mov_b32 v249, 0
    v_mov_b32 v250, 0
    v_mov_b32 v251, 0
    v_mov_b32 v252, 0
    v_mov_b32 v253, 0
    v_mov_b32 v254, 0
    v_mov_b32 v255, 0
    v_mov_b32 v24, 0
    v_mov_b32 v25, 0
    v_mov_b32 v26, 0
    v_mov_b32 v27, 0
    s_add_u32 s56, s61, 16384
    s_cmp_ge_u32 s56, 147456
    s_cselect_b32 s56, 0, s56
    s_mov_b32 s58, 0
    v_add_u32 v20, s61, v1
b_loop:
    s_and_b32 s28, s58, 3
    s_cmp_lg_u32 s28, 0
    s_cbranch_scc1 b_slow2
    s_cmp_lt_u32 s58, 4
    s_cbranch_scc1 b_slow
    s_add_u32 s28, s58, 8
    s_cmp_gt_u32 s28, s50
    s_cbranch_scc1 b_slow
    s_sub_u32 s59, s50, 4
b_fast:
    s_barrier
    s_waitcnt lgkmcnt(0)
    v_mfma_f32_32x32x16_bf16 v[128:143], v[32:35], v[160:163], v[112:127]
    v_add_u32 v21, s56, v1
    s_add_u32 s56, s56, 16384
    s_cmp_ge_u32 s56, 147456
    s_cselect_b32 s56, 0, s56
    ds_read_b128 v[48:51], v20 offset:4096
    ds_read_b128 v[52:55], v20 offset:5120
    ds_read_b128 v[56:59], v20 offset:6144
    ds_read_b128 v[60:63], v20 offset:7168
    v_mfma_f32_32x32x16_bf16 v[128:143], v[36:39], v[164:167], v[128:143]
    v_exp_f32 v144, v144
    v_exp_f32 v145, v145
    v_add_f32 v24, v24, v144
    v_mfma_f32_32x32x16_bf16 v[128:143], v[40:43], v[168:171], v[128:143]
    v_cvt_pk_bf16_f32 v104, v144, v145
    v_exp_f32 v146, v146
    v_add_f32 v25, v25, v145
    v_mfma_f32_32x32x16_bf16 v[128:143], v[44:47], v[172:175], v[128:143]
    v_exp_f32 v147, v147
    v_add_f32 v26, v26, v146
    v_cvt_pk_bf16_f32 v105, v146, v147
    v_exp_f32 v148, v148
    s_waitcnt lgkmcnt(0)
    v_mfma_f32_32x32x16_bf16 v[128:143], v[48:51], v[176:179], v[128:143]
    ds_read_b128 v[32:35], v20 offset:8192
    ds_read_b128 v[36:39], v20 offset:9216
    ds_read_b128 v[40:43], v20 offset:10240
    ds_read_b128 v[44:47], v20 offset:11264
    v_mfma_f32_32x32x16_bf16 v[128:143], v[52:55], v[180:183], v[128:143]
    v_add_f32 v27, v27, v147
    v_exp_f32 v149, v149
    v_add_f32 v24, v24, v148
    v_mfma_f32_32x32x16_bf16 v[128:143], v[56:59], v[184:187], v[128:143]
    v_cvt_pk_bf16_f32 v106, v148, v149
    v_exp_f32 v150, v150
    v_add_f32 v25, v25, v149
    v_mfma_f32_32x32x16_bf16 v[128:143], v[60:63], v[188:191], v[128:143]
    v_exp_f32 v151, v151
    v_add_f32 v26, v26, v150
    v_cvt_pk_bf16_f32 v107, v150, v151
    v_exp_f32 v152, v152
    s_waitcnt lgkmcnt(0)
    v_mfma_f32_32x32x16_bf16 v[192:207], v[32:35], v[96:99], v[192:207]
    ds_read_b128 v[48:51], v20 offset:12288
    ds_read_b128 v[52:55], v20 offset:13312
    ds_read_b128 v[56:59], v20 offset:14336
    ds_read_b128 v[60:63], v20 offset:15360
    v_mfma_f32_32x32x16_bf16 v[208:223], v[36:39], v[96:99], v[208:223]
    v_add_f32 v27, v27, v151
    v_exp_f32 v153, v153
    v_add_f32 v24, v24, v152
    v_mfma_f32_32x32x16_bf16 v[224:239], v[40:43], v[96:99], v[224:239]
    v_cvt_pk_bf16_f32 v108, v152, v153
    v_exp_f32 v154, v154
    v_add_f32 v25, v25, v153
    v_mfma_f32_32x32x16_bf16 v[240:255], v[44:47], v[96:99], v[240:255]
    v_exp_f32 v155, v155
    v_add_f32 v26, v26, v154
    v_cvt_pk_bf16_f32 v109, v154, v155
    v_exp_f32 v156, v156
    s_waitcnt lgkmcnt(0)
    v_mfma_f32_32x32x16_bf16 v[192:207], v[48:51], v[100:103], v[192:207]
    ds_read_b128 v[32:35], v21 offset:0
    ds_read_b128 v[36:39], v21 offset:1024
    ds_read_b128 v[40:43], v21 offset:2048
    ds_read_b128 v[44:47], v21 offset:3072
    v_mfma_f32_32x32x16_bf16 v[208:223], v[52:55], v[100:103], v[208:223]
    v_add_f32 v27, v27, v155
    v_exp_f32 v157, v157
    v_add_f32 v24, v24, v156
    v_mfma_f32_32x32x16_bf16 v[224:239], v[56:59], v[100:103], v[224:239]
    v_cvt_pk_bf16_f32 v110, v156, v157
    v_exp_f32 v158, v158
    v_add_f32 v25, v25, v157
    v_mfma_f32_32x32x16_bf16 v[240:255], v[60:63], v[100:103], v[240:255]
    v_exp_f32 v159, v159
    v_add_f32 v26, v26, v158
    v_cvt_pk_bf16_f32 v111, v158, v159
    v_add_f32 v27, v27, v159
    s_waitcnt lgkmcnt(0)
    v_mfma_f32_32x32x16_bf16 v[144:159], v[32:35], v[160:163], v[112:127]
    v_add_u32 v20, s56, v1
    s_add_u32 s56, s56, 16384
    s_cmp_ge_u32 s56, 147456
    s_cselect_b32 s56, 0, s56
    ds_read_b128 v[48:51], v21 offset:4096
    ds_read_b128 v[52:55], v21 offset:5120
    ds_read_b128 v[56:59], v21 offset:6144
    ds_read_b128 v[60:63], v21 offset:7168
    v_mfma_f32_32x32x16_bf16 v[144:159], v[36:39], v[164:167], v[144:159]
    v_exp_f32 v128, v128
    v_exp_f32 v129, v129
    v_add_f32 v24, v24, v128
    v_mfma_f32_32x32x16_bf16 v[144:159], v[40:43], v[168:171], v[144:159]
    v_cvt_pk_bf16_f32 v96, v128, v129
    v_exp_f32 v130, v130
    v_add_f32 v25, v25, v129
    v_mfma_f32_32x32x16_bf16 v[144:159], v[44:47], v[172:175], v[144:159]
    v_exp_f32 v131, v131
    v_add_f32 v26, v26, v130
    v_cvt_pk_bf16_f32 v97, v130, v131
    v_exp_f32 v132, v132
    s_waitcnt lgkmcnt(0)
    v_mfma_f32_32x32x16_bf16 v[144:159], v[48:51], v[176:179], v[144:159]
    ds_read_b128 v[32:35], v21 offset:8192
    ds_read_b128 v[36:39], v21 offset:9216
    ds_read_b128 v[40:43], v21 offset:10240
    ds_read_b128 v[44:47], v21 offset:11264
    v_mfma_f32_32x32x16_bf16 v[144:159], v[52:55], v[180:183], v[144:159]
    v_add_f32 v27, v27, v131
    v_exp_f32 v133, v133
    v_add_f32 v24, v24, v132
    v_mfma_f32_32x32x16_bf16 v[144:159], v[56:59], v[184:187], v[144:159]
    v_cvt_pk_bf16_f32 v98, v132, v133
    v_exp_f32 v134, v134
    v_add_f32 v25, v25, v133
    v_mfma_f32_32x32x16_bf16 v[144:159], v[60:63], v[188:191], v[144:159]
    v_exp_f32 v135, v135
    v_add_f32 v26, v26, v134
    v_cvt_pk_bf16_f32 v99, v134, v135
    v_exp_f32 v136, v136
    s_waitcnt lgkmcnt(0)
    v_mfma_f32_32x32x16_bf16 v[192:207], v[32:35], v[104:107], v[192:207]
    ds_read_b128 v[48:51], v21 offset:12288
    ds_read_b128 v[52:55], v21 offset:13312
    ds_read_b128 v[56:59], v21 offset:14336
    ds_read_b128 v[60:63], v21 offset:15360
    v_mfma_f32_32x32x16_bf16 v[208:223], v[36:39], v[104:107], v[208:223]
    v_add_f32 v27, v27, v135
    v_exp_f32 v137, v137
    v_add_f32 v24, v24, v136
    v_mfma_f32_32x32x16_bf16 v[224:239], v[40:43], v[104:107], v[224:239]
    v_cvt_pk_bf16_f32 v100, v136, v137
    v_exp_f32 v138, v138
    v_add_f32 v25, v25, v137
    v_mfma_f32_32x32x16_bf16 v[240:255], v[44:47], v[104:107], v[240:255]
    v_exp_f32 v139, v139
    v_add_f32 v26, v26, v138
    v_cvt_pk_bf16_f32 v101, v138, v139
    v_exp_f32 v140, v140
    s_waitcnt lgkmcnt(0)
    v_mfma_f32_32x32x16_bf16 v[192:207], v[48:51], v[108:111], v[192:207]
    ds_read_b128 v[32:35], v20 offset:0
    ds_read_b128 v[36:39], v20 offset:1024
    ds_read_b128 v[40:43], v20 offset:2048
    ds_read_b128 v[44:47], v20 offset:3072
    v_mfma_f32_32x32x16_bf16 v[208:223], v[52:55], v[108:111], v[208:223]
    v_add_f32 v27, v27, v139
    v_exp_f32 v141, v141
    v_add_f32 v24, v24, v140
    v_mfma_f32_32x32x16_bf16 v[224:239], v[56:59], v[108:111], v[224:239]
    v_cvt_pk_bf16_f32 v102, v140, v141
    v_exp_f32 v142, v142
    v_add_f32 v25, v25, v141
    v_mfma_f32_32x32x16_bf16 v[240:255], v[60:63], v[108:111], v[240:255]
    v_exp_f32 v143, v143
    v_add_f32 v26, v26, v142
    v_cvt_pk_bf16_f32 v103, v142, v143
    v_add_f32 v27, v27, v143
    s_waitcnt lgkmcnt(0)
    v_mfma_f32_32x32x16_bf16 v[128:143], v[32:35], v[160:163], v[112:127]
    v_add_u32 v21, s56, v1
    s_add_u32 s56, s56, 16384
    s_cmp_ge_u32 s56, 147456
    s_cselect_b32 s56, 0, s56
    ds_read_b128 v[48:51], v20 offset:4096
    ds_read_b128 v[52:55], v20 offset:5120
    ds_read_b128 v[56:59], v20 offset:6144
    ds_read_b128 v[60:63], v20 offset:7168
    v_mfma_f32_32x32x16_bf16 v[128:143], v[36:39], v[164:167], v[128:143]
    v_exp_f32 v144, v144
    v_exp_f32 v145, v145
    v_add_f32 v24, v24, v144
    v_mfma_f32_32x32x16_bf16 v[128:143], v[40:43], v[168:171], v[128:143]
    v_cvt_pk_bf16_f32 v104, v144, v145
    v_exp_f32 v146, v146
    v_add_f32 v25, v25, v145
    v_mfma_f32_32x32x16_bf16 v[128:143], v[44:47], v[172:175], v[128:143]
    v_exp_f32 v147, v147
    v_add_f32 v26, v26, v146
    v_cvt_pk_bf16_f32 v105, v146, v147
    v_exp_f32 v148, v148
    s_waitcnt lgkmcnt(0)
    v_mfma_f32_32x32x16_bf16 v[128:143], v[48:51], v[176:179], v[128:143]
    ds_read_b128 v[32:35], v20 offset:8192
    ds_read_b128 v[36:39], v20 offset:9216
    ds_read_b128 v[40:43], v20 offset:10240
    ds_read_b128 v[44:47], v20 offset:11264
    v_mfma_f32_32x32x16_bf16 v[128:143], v[52:55], v[180:183], v[128:143]
    v_add_f32 v27, v27, v147
    v_exp_f32 v149, v149
    v_add_f32 v24, v24, v148
    v_mfma_f32_32x32x16_bf16 v[128:143], v[56:59], v[184:187], v[128:143]
    v_cvt_pk_bf16_f32 v106, v148, v149
    v_exp_f32 v150, v150
    v_add_f32 v25, v25, v149
    v_mfma_f32_32x32x16_bf16 v[128:143], v[60:63], v[188:191], v[128:143]
    v_exp_f32 v151, v151
    v_add_f32 v26, v26, v150
    v_cvt_pk_bf16_f32 v107, v150, v151
    v_exp_f32 v152, v152
    s_waitcnt lgkmcnt(0)
    v_mfma_f32_32x32x16_bf16 v[192:207], v[32:35], v[96:99], v[192:207]
    ds_read_b128 v[48:51], v20 offset:12288
    ds_read_b128 v[52:55], v20 offset:13312
    ds_read_b128 v[56:59], v20 offset:14336
    ds_read_b128 v[60:63], v20 offset:15360
    v_mfma_f32_32x32x16_bf16 v[208:223], v[36:39], v[96:99], v[208:223]
    v_add_f32 v27, v27, v151
    v_exp_f32 v153, v153
    v_add_f32 v24, v24, v152
    v_mfma_f32_32x32x16_bf16 v[224:239], v[40:43], v[96:99], v[224:239]
    v_cvt_pk_bf16_f32 v108, v152, v153
    v_exp_f32 v154, v154
    v_add_f32 v25, v25, v153
    v_mfma_f32_32x32x16_bf16 v[240:255], v[44:47], v[96:99], v[240:255]
    v_exp_f32 v155, v155
    v_add_f32 v26, v26, v154
    v_cvt_pk_bf16_f32 v109, v154, v155
    v_exp_f32 v156, v156
    s_waitcnt lgkmcnt(0)
    v_mfma_f32_32x32x16_bf16 v[192:207], v[48:51], v[100:103], v[192:207]
    ds_read_b128 v[32:35], v21 offset:0
    ds_read_b128 v[36:39], v21 offset:1024
    ds_read_b128 v[40:43], v21 offset:2048
    ds_read_b128 v[44:47], v21 offset:3072
    v_mfma_f32_32x32x16_bf16 v[208:223], v[52:55], v[100:103], v[208:223]
    v_add_f32 v27, v27, v155
    v_exp_f32 v157, v157
    v_add_f32 v24, v24, v156
    v_mfma_f32_32x32x16_bf16 v[224:239], v[56:59], v[100:103], v[224:239]
    v_cvt_pk_bf16_f32 v110, v156, v157
    v_exp_f32 v158, v158
    v_add_f32 v25, v25, v157
    v_mfma_f32_32x32x16_bf16 v[240:255], v[60:63], v[100:103], v[240:255]
    v_exp_f32 v159, v159
    v_add_f32 v26, v26, v158
    v_cvt_pk_bf16_f32 v111, v158, v159
    v_add_f32 v27, v27, v159
    s_waitcnt lgkmcnt(0)
    v_mfma_f32_32x32x16_bf16 v[144:159], v[32:35], v[160:163], v[112:127]
    v_add_u32 v20, s56, v1
    s_add_u32 s56, s56, 16384
    s_cmp_ge_u32 s56, 147456
    s_cselect_b32 s56, 0, s56
    s_add_u32 s58, s58, 4
    ds_read_b128 v[48:51], v21 offset:4096
    ds_read_b128 v[52:55], v21 offset:5120
    ds_read_b128 v[56:59], v21 offset:6144
    ds_read_b128 v[60:63], v21 offset:7168
    v_mfma_f32_32x32x16_bf16 v[144:159], v[36:39], v[164:167], v[144:159]
    v_exp_f32 v128, v128
    v_exp_f32 v129, v129
    v_add_f32 v24, v24, v128
    v_mfma_f32_32x32x16_bf16 v[144:159], v[40:43], v[168:171], v[144:159]
    v_cvt_pk_bf16_f32 v96, v128, v129
    v_exp_f32 v130, v130
    v_add_f32 v25, v25, v129
    v_mfma_f32_32x32x16_bf16 v[144:159], v[44:47], v[172:175], v[144:159]
    v_exp_f32 v131, v131
    v_add_f32 v26, v26, v130
    v_cvt_pk_bf16_f32 v97, v130, v131
    v_exp_f32 v132, v132
    s_waitcnt lgkmcnt(0)
    v_mfma_f32_32x32x16_bf16 v[144:159], v[48:51], v[176:179], v[144:159]
    ds_read_b128 v[32:35], v21 offset:8192
    ds_read_b128 v[36:39], v21 offset:9216
    ds_read_b128 v[40:43], v21 offset:10240
    ds_read_b128 v[44:47], v21 offset:11264
    v_mfma_f32_32x32x16_bf16 v[144:159], v[52:55], v[180:183], v[144:159]
    v_add_f32 v27, v27, v131
    v_exp_f32 v133, v133
    v_add_f32 v24, v24, v132
    v_mfma_f32_32x32x16_bf16 v[144:159], v[56:59], v[184:187], v[144:159]
    v_cvt_pk_bf16_f32 v98, v132, v133
    v_exp_f32 v134, v134
    v_add_f32 v25, v25, v133
    v_mfma_f32_32x32x16_bf16 v[144:159], v[60:63], v[188:191], v[144:159]
    v_exp_f32 v135, v135
    v_add_f32 v26, v26, v134
    v_cvt_pk_bf16_f32 v99, v134, v135
    v_exp_f32 v136, v136
    s_waitcnt lgkmcnt(0)
    v_mfma_f32_32x32x16_bf16 v[192:207], v[32:35], v[104:107], v[192:207]
    ds_read_b128 v[48:51], v21 offset:12288
    ds_read_b128 v[52:55], v21 offset:13312
    ds_read_b128 v[56:59], v21 offset:14336
    ds_read_b128 v[60:63], v21 offset:15360
    v_mfma_f32_32x32x16_bf16 v[208:223], v[36:39], v[104:107], v[208:223]
    v_add_f32 v27, v27, v135
    v_exp_f32 v137, v137
    v_add_f32 v24, v24, v136
    v_mfma_f32_32x32x16_bf16 v[224:239], v[40:43], v[104:107], v[224:239]
    v_cvt_pk_bf16_f32 v100, v136, v137
    v_exp_f32 v138, v138
    v_add_f32 v25, v25, v137
    v_mfma_f32_32x32x16_bf16 v[240:255], v[44:47], v[104:107], v[240:255]
    v_exp_f32 v139, v139
    v_add_f32 v26, v26, v138
    v_cvt_pk_bf16_f32 v101, v138, v139
    v_exp_f32 v140, v140
    s_waitcnt lgkmcnt(0)
    v_mfma_f32_32x32x16_bf16 v[192:207], v[48:51], v[108:111], v[192:207]
    ds_read_b128 v[32:35], v20 offset:0
    ds_read_b128 v[36:39], v20 offset:1024
    ds_read_b128 v[40:43], v20 offset:2048
    ds_read_b128 v[44:47], v20 offset:3072
    v_mfma_f32_32x32x16_bf16 v[208:223], v[52:55], v[108:111], v[208:223]
    v_add_f32 v27, v27, v139
    v_exp_f32 v141, v141
    v_add_f32 v24, v24, v140
    v_mfma_f32_32x32x16_bf16 v[224:239], v[56:59], v[108:111], v[224:239]
    v_cvt_pk_bf16_f32 v102, v140, v141
    v_exp_f32 v142, v142
    v_add_f32 v25, v25, v141
    v_mfma_f32_32x32x16_bf16 v[240:255], v[60:63], v[108:111], v[240:255]
    s_cmp_lt_u32 s58, s59
    v_exp_f32 v143, v143
    v_add_f32 v26, v26, v142
    v_cvt_pk_bf16_f32 v103, v142, v143
    v_add_f32 v27, v27, v143
    s_cbranch_scc1 b_fast
b_slow:
    s_barrier
b_slow2:
    s_add_u32 s28, s58, 1
    s_cmp_lg_u32 s28, s49
    s_cbranch_scc1 b_nodiag_6
    v_mov_b32 v19, 0xff800000
    v_cmp_gt_i32 vcc, 0, v18
    s_nop 1
    v_cndmask_b32 v112, v112, v19, vcc
    v_cmp_gt_i32 vcc, 1, v18
    s_nop 1
    v_cndmask_b32 v113, v113, v19, vcc
    v_cmp_gt_i32 vcc, 2, v18
    s_nop 1
    v_cndmask_b32 v114, v114, v19, vcc
    v_cmp_gt_i32 vcc, 3, v18
    s_nop 1
    v_cndmask_b32 v115, v115, v19, vcc
    v_cmp_gt_i32 vcc, 8, v18
    s_nop 1
    v_cndmask_b32 v116, v116, v19, vcc
    v_cmp_gt_i32 vcc, 9, v18
    s_nop 1
    v_cndmask_b32 v117, v117, v19, vcc
    v_cmp_gt_i32 vcc, 10, v18
    s_nop 1
    v_cndmask_b32 v118, v118, v19, vcc
    v_cmp_gt_i32 vcc, 11, v18
    s_nop 1
    v_cndmask_b32 v119, v119, v19, vcc
    v_cmp_gt_i32 vcc, 16, v18
    s_nop 1
    v_cndmask_b32 v120, v120, v19, vcc
    v_cmp_gt_i32 vcc, 17, v18
    s_nop 1
    v_cndmask_b32 v121, v121, v19, vcc
    v_cmp_gt_i32 vcc, 18, v18
    s_nop 1
    v_cndmask_b32 v122, v122, v19, vcc
    v_cmp_gt_i32 vcc, 19, v18
    s_nop 1
    v_cndmask_b32 v123, v123, v19, vcc
    v_cmp_gt_i32 vcc, 24, v18
    s_nop 1
    v_cndmask_b32 v124, v124, v19, vcc
    v_cmp_gt_i32 vcc, 25, v18
    s_nop 1
    v_cndmask_b32 v125, v125, v19, vcc
    v_cmp_gt_i32 vcc, 26, v18
    s_nop 1
    v_cndmask_b32 v126, v126, v19, vcc
    v_cmp_gt_i32 vcc, 27, v18
    s_nop 1
    v_cndmask_b32 v127, v127, v19, vcc
b_nodiag_6:
    s_cmp_lt_u32 s58, 2
    s_cbranch_scc1 b_nonsteady_5
    s_cmp_ge_u32 s58, s49
    s_cbranch_scc1 b_nonsteady_5
    s_waitcnt lgkmcnt(0)
    v_mfma_f32_32x32x16_bf16 v[128:143], v[32:35], v[160:163], v[112:127]
    v_add_u32 v21, s56, v1
    s_add_u32 s56, s56, 16384
    s_cmp_ge_u32 s56, 147456
    s_cselect_b32 s56, 0, s56
    ds_read_b128 v[48:51], v20 offset:4096
    ds_read_b128 v[52:55], v20 offset:5120
    ds_read_b128 v[56:59], v20 offset:6144
    ds_read_b128 v[60:63], v20 offset:7168
    v_mfma_f32_32x32x16_bf16 v[128:143], v[36:39], v[164:167], v[128:143]
    v_exp_f32 v144, v144
    v_exp_f32 v145, v145
    v_add_f32 v24, v24, v144
    v_mfma_f32_32x32x16_bf16 v[128:143], v[40:43], v[168:171], v[128:143]
    v_cvt_pk_bf16_f32 v104, v144, v145
    v_exp_f32 v146, v146
    v_add_f32 v25, v25, v145
    v_mfma_f32_32x32x16_bf16 v[128:143], v[44:47], v[172:175], v[128:143]
    v_exp_f32 v147, v147
    v_add_f32 v26, v26, v146
    v_cvt_pk_bf16_f32 v105, v146, v147
    v_exp_f32 v148, v148
    s_waitcnt lgkmcnt(0)
    v_mfma_f32_32x32x16_bf16 v[128:143], v[48:51], v[176:179], v[128:143]
    ds_read_b128 v[32:35], v20 offset:8192
    ds_read_b128 v[36:39], v20 offset:9216
    ds_read_b128 v[40:43], v20 offset:10240
    ds_read_b128 v[44:47], v20 offset:11264
    v_mfma_f32_32x32x16_bf16 v[128:143], v[52:55], v[180:183], v[128:143]
    v_add_f32 v27, v27, v147
    v_exp_f32 v149, v149
    v_add_f32 v24, v24, v148
    v_mfma_f32_32x32x16_bf16 v[128:143], v[56:59], v[184:187], v[128:143]
    v_cvt_pk_bf16_f32 v106, v148, v149
    v_exp_f32 v150, v150
    v_add_f32 v25, v25, v149
    v_mfma_f32_32x32x16_bf16 v[128:143], v[60:63], v[188:191], v[128:143]
    v_exp_f32 v151, v151
    v_add_f32 v26, v26, v150
    v_cvt_pk_bf16_f32 v107, v150, v151
    v_exp_f32 v152, v152
    s_waitcnt lgkmcnt(0)
    v_mfma_f32_32x32x16_bf16 v[192:207], v[32:35], v[96:99], v[192:207]
    ds_read_b128 v[48:51], v20 offset:12288
    ds_read_b128 v[52:55], v20 offset:13312
    ds_read_b128 v[56:59], v20 offset:14336
    ds_read_b128 v[60:63], v20 offset:15360
    v_mfma_f32_32x32x16_bf16 v[208:223], v[36:39], v[96:99], v[208:223]
    v_add_f32 v27, v27, v151
    v_exp_f32 v153, v153
    v_add_f32 v24, v24, v152
    v_mfma_f32_32x32x16_bf16 v[224:239], v[40:43], v[96:99], v[224:239]
    v_cvt_pk_bf16_f32 v108, v152, v153
    v_exp_f32 v154, v154
    v_add_f32 v25, v25, v153
    v_mfma_f32_32x32x16_bf16 v[240:255], v[44:47], v[96:99], v[240:255]
    v_exp_f32 v155, v155
    v_add_f32 v26, v26, v154
    v_cvt_pk_bf16_f32 v109, v154, v155
    v_exp_f32 v156, v156
    s_waitcnt lgkmcnt(0)
    v_mfma_f32_32x32x16_bf16 v[192:207], v[48:51], v[100:103], v[192:207]
    ds_read_b128 v[32:35], v21 offset:0
    ds_read_b128 v[36:39], v21 offset:1024
    ds_read_b128 v[40:43], v21 offset:2048
    ds_read_b128 v[44:47], v21 offset:3072
    v_mfma_f32_32x32x16_bf16 v[208:223], v[52:55], v[100:103], v[208:223]
    v_add_f32 v27, v27, v155
    v_exp_f32 v157, v157
    v_add_f32 v24, v24, v156
    v_mfma_f32_32x32x16_bf16 v[224:239], v[56:59], v[100:103], v[224:239]
    v_cvt_pk_bf16_f32 v110, v156, v157
    v_exp_f32 v158, v158
    v_add_f32 v25, v25, v157
    v_mfma_f32_32x32x16_bf16 v[240:255], v[60:63], v[100:103], v[240:255]
    v_exp_f32 v159, v159
    v_add_f32 v26, v26, v158
    v_cvt_pk_bf16_f32 v111, v158, v159
    v_add_f32 v27, v27, v159
    s_branch b_next_4
b_nonsteady_5:
    s_cmp_ge_u32 s58, s49
    s_cbranch_scc1 b_ge_7
    s_cmp_eq_u32 s60, 0
    s_cbranch_scc1 b_g0raw_11
    ds_read_b128 v[32:35], v20 offset:0
    ds_read_b128 v[36:39], v20 offset:1024
    ds_read_b128 v[40:43], v20 offset:2048
    ds_read_b128 v[44:47], v20 offset:3072
    s_waitcnt lgkmcnt(0)
    v_mfma_f32_32x32x16_bf16 v[128:143], v[32:35], v[160:163], v[112:127]
    v_add_u32 v21, s56, v1
    s_add_u32 s56, s56, 16384
    s_cmp_ge_u32 s56, 147456
    s_cselect_b32 s56, 0, s56
    ds_read_b128 v[48:51], v20 offset:4096
    ds_read_b128 v[52:55], v20 offset:5120
    ds_read_b128 v[56:59], v20 offset:6144
    ds_read_b128 v[60:63], v20 offset:7168
    v_mfma_f32_32x32x16_bf16 v[128:143], v[36:39], v[164:167], v[128:143]
    v_mfma_f32_32x32x16_bf16 v[128:143], v[40:43], v[168:171], v[128:143]
    v_mfma_f32_32x32x16_bf16 v[128:143], v[44:47], v[172:175], v[128:143]
    s_waitcnt lgkmcnt(0)
    v_mfma_f32_32x32x16_bf16 v[128:143], v[48:51], v[176:179], v[128:143]
    ds_read_b128 v[32:35], v21 offset:0
    ds_read_b128 v[36:39], v21 offset:1024
    ds_read_b128 v[40:43], v21 offset:2048
    ds_read_b128 v[44:47], v21 offset:3072
    v_mfma_f32_32x32x16_bf16 v[128:143], v[52:55], v[180:183], v[128:143]
    v_mfma_f32_32x32x16_bf16 v[128:143], v[56:59], v[184:187], v[128:143]
    v_mfma_f32_32x32x16_bf16 v[128:143], v[60:63], v[188:191], v[128:143]
    s_branch b_next_4
b_g0raw_11:
    ds_read_b128 v[32:35], v20 offset:0
    ds_read_b128 v[36:39], v20 offset:1024
    ds_read_b128 v[40:43], v20 offset:2048
    ds_read_b128 v[44:47], v20 offset:3072
    s_waitcnt lgkmcnt(0)
    v_mfma_f32_32x32x16_bf16 v[128:143], v[32:35], v[160:163], 0
    v_add_u32 v21, s56, v1
    s_add_u32 s56, s56, 16384
    s_cmp_ge_u32 s56, 147456
    s_cselect_b32 s56, 0, s56
    ds_read_b128 v[48:51], v20 offset:4096
    ds_read_b128 v[52:55], v20 offset:5120
    ds_read_b128 v[56:59], v20 offset:6144
    ds_read_b128 v[60:63], v20 offset:7168
    v_mfma_f32_32x32x16_bf16 v[128:143], v[36:39], v[164:167], v[128:143]
    v_mfma_f32_32x32x16_bf16 v[128:143], v[40:43], v[168:171], v[128:143]
    v_mfma_f32_32x32x16_bf16 v[128:143], v[44:47], v[172:175], v[128:143]
    s_waitcnt lgkmcnt(0)
    v_mfma_f32_32x32x16_bf16 v[128:143], v[48:51], v[176:179], v[128:143]
    ds_read_b128 v[32:35], v21 offset:0
    ds_read_b128 v[36:39], v21 offset:1024
    ds_read_b128 v[40:43], v21 offset:2048
    ds_read_b128 v[44:47], v21 offset:3072
    v_mfma_f32_32x32x16_bf16 v[128:143], v[52:55], v[180:183], v[128:143]
    v_mfma_f32_32x32x16_bf16 v[128:143], v[56:59], v[184:187], v[128:143]
    v_mfma_f32_32x32x16_bf16 v[128:143], v[60:63], v[188:191], v[128:143]
    s_nop 15
    s_cmp_lg_u32 s49, 1
    s_cbranch_scc1 b_nomask0_12
    v_mov_b32 v19, 0xff800000
    v_cmp_gt_i32 vcc, 0, v18
    s_nop 1
    v_cndmask_b32 v128, v128, v19, vcc
    v_cmp_gt_i32 vcc, 1, v18
    s_nop 1
    v_cndmask_b32 v129, v129, v19, vcc
    v_cmp_gt_i32 vcc, 2, v18
    s_nop 1
    v_cndmask_b32 v130, v130, v19, vcc
    v_cmp_gt_i32 vcc, 3, v18
    s_nop 1
    v_cndmask_b32 v131, v131, v19, vcc
    v_cmp_gt_i32 vcc, 8, v18
    s_nop 1
    v_cndmask_b32 v132, v132, v19, vcc
    v_cmp_gt_i32 vcc, 9, v18
    s_nop 1
    v_cndmask_b32 v133, v133, v19, vcc
    v_cmp_gt_i32 vcc, 10, v18
    s_nop 1
    v_cndmask_b32 v134, v134, v19, vcc
    v_cmp_gt_i32 vcc, 11, v18
    s_nop 1
    v_cndmask_b32 v135, v135, v19, vcc
    v_cmp_gt_i32 vcc, 16, v18
    s_nop 1
    v_cndmask_b32 v136, v136, v19, vcc
    v_cmp_gt_i32 vcc, 17, v18
    s_nop 1
    v_cndmask_b32 v137, v137, v19, vcc
    v_cmp_gt_i32 vcc, 18, v18
    s_nop 1
    v_cndmask_b32 v138, v138, v19, vcc
    v_cmp_gt_i32 vcc, 19, v18
    s_nop 1
    v_cndmask_b32 v139, v139, v19, vcc
    v_cmp_gt_i32 vcc, 24, v18
    s_nop 1
    v_cndmask_b32 v140, v140, v19, vcc
    v_cmp_gt_i32 vcc, 25, v18
    s_nop 1
    v_cndmask_b32 v141, v141, v19, vcc
    v_cmp_gt_i32 vcc, 26, v18
    s_nop 1
    v_cndmask_b32 v142, v142, v19, vcc
    v_cmp_gt_i32 vcc, 27, v18
    s_nop 1
    v_cndmask_b32 v143, v143, v19, vcc
b_nomask0_12:
    v_max3_f32 v22, v128, v129, v130
    v_max3_f32 v22, v22, v131, v132
    v_max3_f32 v22, v22, v133, v134
    v_max3_f32 v22, v22, v135, v136
    v_max3_f32 v22, v22, v137, v138
    v_max3_f32 v22, v22, v139, v140
    v_max3_f32 v22, v22, v141, v142
    v_max_f32 v22, v22, v143
    v_mov_b32 v19, v22
    s_nop 1
    v_permlane32_swap_b32 v19, v22
    s_nop 1
    v_max_f32 v22, v22, v19
    v_sub_f32 v128, v128, v22
    v_sub_f32 v129, v129, v22
    v_sub_f32 v130, v130, v22
    v_sub_f32 v131, v131, v22
    v_sub_f32 v132, v132, v22
    v_sub_f32 v133, v133, v22
    v_sub_f32 v134, v134, v22
    v_sub_f32 v135, v135, v22
    v_sub_f32 v136, v136, v22
    v_sub_f32 v137, v137, v22
    v_sub_f32 v138, v138, v22
    v_sub_f32 v139, v139, v22
    v_sub_f32 v140, v140, v22
    v_sub_f32 v141, v141, v22
    v_sub_f32 v142, v142, v22
    v_sub_f32 v143, v143, v22
    v_sub_f32 v112, 0, v22
    v_sub_f32 v113, 0, v22
    v_sub_f32 v114, 0, v22
    v_sub_f32 v115, 0, v22
    v_sub_f32 v116, 0, v22
    v_sub_f32 v117, 0, v22
    v_sub_f32 v118, 0, v22
    v_sub_f32 v119, 0, v22
    v_sub_f32 v120, 0, v22
    v_sub_f32 v121, 0, v22
    v_sub_f32 v122, 0, v22
    v_sub_f32 v123, 0, v22
    v_sub_f32 v124, 0, v22
    v_sub_f32 v125, 0, v22
    v_sub_f32 v126, 0, v22
    v_sub_f32 v127, 0, v22
    s_branch b_next_4
b_ge_7:
    s_cmp_eq_u32 s58, s49
    s_cbranch_scc0 b_pv_8
    s_cmp_lt_u32 s58, 2
    s_cbranch_scc1 b_sm_10
    ds_read_b128 v[32:35], v20 offset:8192
    ds_read_b128 v[36:39], v20 offset:9216
    ds_read_b128 v[40:43], v20 offset:10240
    ds_read_b128 v[44:47], v20 offset:11264
    s_waitcnt lgkmcnt(0)
    v_mfma_f32_32x32x16_bf16 v[192:207], v[32:35], v[96:99], v[192:207]
    v_add_u32 v21, s56, v1
    s_add_u32 s56, s56, 16384
    s_cmp_ge_u32 s56, 147456
    s_cselect_b32 s56, 0, s56
    ds_read_b128 v[48:51], v20 offset:12288
    ds_read_b128 v[52:55], v20 offset:13312
    ds_read_b128 v[56:59], v20 offset:14336
    ds_read_b128 v[60:63], v20 offset:15360
    v_mfma_f32_32x32x16_bf16 v[208:223], v[36:39], v[96:99], v[208:223]
    v_exp_f32 v144, v144
    v_exp_f32 v145, v145
    v_add_f32 v24, v24, v144
    v_cvt_pk_bf16_f32 v104, v144, v145
    v_exp_f32 v146, v146
    v_add_f32 v25, v25, v145
    v_mfma_f32_32x32x16_bf16 v[224:239], v[40:43], v[96:99], v[224:239]
    v_exp_f32 v147, v147
    v_add_f32 v26, v26, v146
    v_cvt_pk_bf16_f32 v105, v146, v147
    v_exp_f32 v148, v148
    v_add_f32 v27, v27, v147
    v_exp_f32 v149, v149
    v_add_f32 v24, v24, v148
    v_mfma_f32_32x32x16_bf16 v[240:255], v[44:47], v[96:99], v[240:255]
    v_cvt_pk_bf16_f32 v106, v148, v149
    v_exp_f32 v150, v150
    v_add_f32 v25, v25, v149
    v_exp_f32 v151, v151
    v_add_f32 v26, v26, v150
    v_cvt_pk_bf16_f32 v107, v150, v151
    v_exp_f32 v152, v152
    s_waitcnt lgkmcnt(0)
    v_mfma_f32_32x32x16_bf16 v[192:207], v[48:51], v[100:103], v[192:207]
    v_mfma_f32_32x32x16_bf16 v[208:223], v[52:55], v[100:103], v[208:223]
    v_add_f32 v27, v27, v151
    v_exp_f32 v153, v153
    v_add_f32 v24, v24, v152
    v_cvt_pk_bf16_f32 v108, v152, v153
    v_exp_f32 v154, v154
    v_add_f32 v25, v25, v153
    v_mfma_f32_32x32x16_bf16 v[224:239], v[56:59], v[100:103], v[224:239]
    v_exp_f32 v155, v155
    v_add_f32 v26, v26, v154
    v_cvt_pk_bf16_f32 v109, v154, v155
    v_exp_f32 v156, v156
    v_add_f32 v27, v27, v155
    v_exp_f32 v157, v157
    v_add_f32 v24, v24, v156
    v_mfma_f32_32x32x16_bf16 v[240:255], v[60:63], v[100:103], v[240:255]
    v_cvt_pk_bf16_f32 v110, v156, v157
    v_exp_f32 v158, v158
    v_add_f32 v25, v25, v157
    v_exp_f32 v159, v159
    v_add_f32 v26, v26, v158
    v_cvt_pk_bf16_f32 v111, v158, v159
    v_add_f32 v27, v27, v159
    s_branch b_next_4
b_sm_10:
    v_add_u32 v21, s56, v1
    s_add_u32 s56, s56, 16384
    s_cmp_ge_u32 s56, 147456
    s_cselect_b32 s56, 0, s56
    v_exp_f32 v144, v144
    v_exp_f32 v145, v145
    v_add_f32 v24, v24, v144
    v_cvt_pk_bf16_f32 v104, v144, v145
    v_exp_f32 v146, v146
    v_add_f32 v25, v25, v145
    v_exp_f32 v147, v147
    v_add_f32 v26, v26, v146
    v_cvt_pk_bf16_f32 v105, v146, v147
    v_exp_f32 v148, v148
    v_add_f32 v27, v27, v147
    v_exp_f32 v149, v149
    v_add_f32 v24, v24, v148
    v_cvt_pk_bf16_f32 v106, v148, v149
    v_exp_f32 v150, v150
    v_add_f32 v25, v25, v149
    v_exp_f32 v151, v151
    v_add_f32 v26, v26, v150
    v_cvt_pk_bf16_f32 v107, v150, v151
    v_exp_f32 v152, v152
    v_add_f32 v27, v27, v151
    v_exp_f32 v153, v153
    v_add_f32 v24, v24, v152
    v_cvt_pk_bf16_f32 v108, v152, v153
    v_exp_f32 v154, v154
    v_add_f32 v25, v25, v153
    v_exp_f32 v155, v155
    v_add_f32 v26, v26, v154
    v_cvt_pk_bf16_f32 v109, v154, v155
    v_exp_f32 v156, v156
    v_add_f32 v27, v27, v155
    v_exp_f32 v157, v157
    v_add_f32 v24, v24, v156
    v_cvt_pk_bf16_f32 v110, v156, v157
    v_exp_f32 v158, v158
    v_add_f32 v25, v25, v157
    v_exp_f32 v159, v159
    v_add_f32 v26, v26, v158
    v_cvt_pk_bf16_f32 v111, v158, v159
    v_add_f32 v27, v27, v159
    s_branch b_next_4
b_pv_8:
    s_add_u32 s28, s49, 1
    s_cmp_eq_u32 s58, s28
    s_cbranch_scc0 b_none_9
    s_nop 1
    ds_read_b128 v[32:35], v20 offset:8192
    ds_read_b128 v[36:39], v20 offset:9216
    ds_read_b128 v[40:43], v20 offset:10240
    ds_read_b128 v[44:47], v20 offset:11264
    s_waitcnt lgkmcnt(0)
    v_mfma_f32_32x32x16_bf16 v[192:207], v[32:35], v[96:99], v[192:207]
    v_add_u32 v21, s56, v1
    s_add_u32 s56, s56, 16384
    s_cmp_ge_u32 s56, 147456
    s_cselect_b32 s56, 0, s56
    ds_read_b128 v[48:51], v20 offset:12288
    ds_read_b128 v[52:55], v20 offset:13312
    ds_read_b128 v[56:59], v20 offset:14336
    ds_read_b128 v[60:63], v20 offset:15360
    v_mfma_f32_32x32x16_bf16 v[208:223], v[36:39], v[96:99], v[208:223]
    v_mfma_f32_32x32x16_bf16 v[224:239], v[40:43], v[96:99], v[224:239]
    v_mfma_f32_32x32x16_bf16 v[240:255], v[44:47], v[96:99], v[240:255]
    s_waitcnt lgkmcnt(0)
    v_mfma_f32_32x32x16_bf16 v[192:207], v[48:51], v[100:103], v[192:207]
    v_mfma_f32_32x32x16_bf16 v[208:223], v[52:55], v[100:103], v[208:223]
    v_mfma_f32_32x32x16_bf16 v[224:239], v[56:59], v[100:103], v[224:239]
    v_mfma_f32_32x32x16_bf16 v[240:255], v[60:63], v[100:103], v[240:255]
    s_branch b_next_4
b_none_9:
    v_add_u32 v21, s56, v1
    s_add_u32 s56, s56, 16384
    s_cmp_ge_u32 s56, 147456
    s_cselect_b32 s56, 0, s56
b_next_4:
    s_add_u32 s58, s58, 1
    s_add_u32 s28, s58, 1
    s_cmp_lg_u32 s28, s49
    s_cbranch_scc1 b_nodiag_15
    v_mov_b32 v19, 0xff800000
    v_cmp_gt_i32 vcc, 0, v18
    s_nop 1
    v_cndmask_b32 v112, v112, v19, vcc
    v_cmp_gt_i32 vcc, 1, v18
    s_nop 1
    v_cndmask_b32 v113, v113, v19, vcc
    v_cmp_gt_i32 vcc, 2, v18
    s_nop 1
    v_cndmask_b32 v114, v114, v19, vcc
    v_cmp_gt_i32 vcc, 3, v18
    s_nop 1
    v_cndmask_b32 v115, v115, v19, vcc
    v_cmp_gt_i32 vcc, 8, v18
    s_nop 1
    v_cndmask_b32 v116, v116, v19, vcc
    v_cmp_gt_i32 vcc, 9, v18
    s_nop 1
    v_cndmask_b32 v117, v117, v19, vcc
    v_cmp_gt_i32 vcc, 10, v18
    s_nop 1
    v_cndmask_b32 v118, v118, v19, vcc
    v_cmp_gt_i32 vcc, 11, v18
    s_nop 1
    v_cndmask_b32 v119, v119, v19, vcc
    v_cmp_gt_i32 vcc, 16, v18
    s_nop 1
    v_cndmask_b32 v120, v120, v19, vcc
    v_cmp_gt_i32 vcc, 17, v18
    s_nop 1
    v_cndmask_b32 v121, v121, v19, vcc
    v_cmp_gt_i32 vcc, 18, v18
    s_nop 1
    v_cndmask_b32 v122, v122, v19, vcc
    v_cmp_gt_i32 vcc, 19, v18
    s_nop 1
    v_cndmask_b32 v123, v123, v19, vcc
    v_cmp_gt_i32 vcc, 24, v18
    s_nop 1
    v_cndmask_b32 v124, v124, v19, vcc
    v_cmp_gt_i32 vcc, 25, v18
    s_nop 1
    v_cndmask_b32 v125, v125, v19, vcc
    v_cmp_gt_i32 vcc, 26, v18
    s_nop 1
    v_cndmask_b32 v126, v126, v19, vcc
    v_cmp_gt_i32 vcc, 27, v18
    s_nop 1
    v_cndmask_b32 v127, v127, v19, vcc
b_nodiag_15:
    s_cmp_lt_u32 s58, 2
    s_cbranch_scc1 b_nonsteady_14
    s_cmp_ge_u32 s58, s49
    s_cbranch_scc1 b_nonsteady_14
    s_waitcnt lgkmcnt(0)
    v_mfma_f32_32x32x16_bf16 v[144:159], v[32:35], v[160:163], v[112:127]
    v_add_u32 v20, s56, v1
    s_add_u32 s56, s56, 16384
    s_cmp_ge_u32 s56, 147456
    s_cselect_b32 s56, 0, s56
    ds_read_b128 v[48:51], v21 offset:4096
    ds_read_b128 v[52:55], v21 offset:5120
    ds_read_b128 v[56:59], v21 offset:6144
    ds_read_b128 v[60:63], v21 offset:7168
    v_mfma_f32_32x32x16_bf16 v[144:159], v[36:39], v[164:167], v[144:159]
    v_exp_f32 v128, v128
    v_exp_f32 v129, v129
    v_add_f32 v24, v24, v128
    v_mfma_f32_32x32x16_bf16 v[144:159], v[40:43], v[168:171], v[144:159]
    v_cvt_pk_bf16_f32 v96, v128, v129
    v_exp_f32 v130, v130
    v_add_f32 v25, v25, v129
    v_mfma_f32_32x32x16_bf16 v[144:159], v[44:47], v[172:175], v[144:159]
    v_exp_f32 v131, v131
    v_add_f32 v26, v26, v130
    v_cvt_pk_bf16_f32 v97, v130, v131
    v_exp_f32 v132, v132
    s_waitcnt lgkmcnt(0)
    v_mfma_f32_32x32x16_bf16 v[144:159], v[48:51], v[176:179], v[144:159]
    ds_read_b128 v[32:35], v21 offset:8192
    ds_read_b128 v[36:39], v21 offset:9216
    ds_read_b128 v[40:43], v21 offset:10240
    ds_read_b128 v[44:47], v21 offset:11264
    v_mfma_f32_32x32x16_bf16 v[144:159], v[52:55], v[180:183], v[144:159]
    v_add_f32 v27, v27, v131
    v_exp_f32 v133, v133
    v_add_f32 v24, v24, v132
    v_mfma_f32_32x32x16_bf16 v[144:159], v[56:59], v[184:187], v[144:159]
    v_cvt_pk_bf16_f32 v98, v132, v133
    v_exp_f32 v134, v134
    v_add_f32 v25, v25, v133
    v_mfma_f32_32x32x16_bf16 v[144:159], v[60:63], v[188:191], v[144:159]
    v_exp_f32 v135, v135
    v_add_f32 v26, v26, v134
    v_cvt_pk_bf16_f32 v99, v134, v135
    v_exp_f32 v136, v136
    s_waitcnt lgkmcnt(0)
    v_mfma_f32_32x32x16_bf16 v[192:207], v[32:35], v[104:107], v[192:207]
    ds_read_b128 v[48:51], v21 offset:12288
    ds_read_b128 v[52:55], v21 offset:13312
    ds_read_b128 v[56:59], v21 offset:14336
    ds_read_b128 v[60:63], v21 offset:15360
    v_mfma_f32_32x32x16_bf16 v[208:223], v[36:39], v[104:107], v[208:223]
    v_add_f32 v27, v27, v135
    v_exp_f32 v137, v137
    v_add_f32 v24, v24, v136
    v_mfma_f32_32x32x16_bf16 v[224:239], v[40:43], v[104:107], v[224:239]
    v_cvt_pk_bf16_f32 v100, v136, v137
    v_exp_f32 v138, v138
    v_add_f32 v25, v25, v137
    v_mfma_f32_32x32x16_bf16 v[240:255], v[44:47], v[104:107], v[240:255]
    v_exp_f32 v139, v139
    v_add_f32 v26, v26, v138
    v_cvt_pk_bf16_f32 v101, v138, v139
    v_exp_f32 v140, v140
    s_waitcnt lgkmcnt(0)
    v_mfma_f32_32x32x16_bf16 v[192:207], v[48:51], v[108:111], v[192:207]
    ds_read_b128 v[32:35], v20 offset:0
    ds_read_b128 v[36:39], v20 offset:1024
    ds_read_b128 v[40:43], v20 offset:2048
    ds_read_b128 v[44:47], v20 offset:3072
    v_mfma_f32_32x32x16_bf16 v[208:223], v[52:55], v[108:111], v[208:223]
    v_add_f32 v27, v27, v139
    v_exp_f32 v141, v141
    v_add_f32 v24, v24, v140
    v_mfma_f32_32x32x16_bf16 v[224:239], v[56:59], v[108:111], v[224:239]
    v_cvt_pk_bf16_f32 v102, v140, v141
    v_exp_f32 v142, v142
    v_add_f32 v25, v25, v141
    v_mfma_f32_32x32x16_bf16 v[240:255], v[60:63], v[108:111], v[240:255]
    v_exp_f32 v143, v143
    v_add_f32 v26, v26, v142
    v_cvt_pk_bf16_f32 v103, v142, v143
    v_add_f32 v27, v27, v143
    s_branch b_next_13
b_nonsteady_14:
    s_cmp_ge_u32 s58, s49
    s_cbranch_scc1 b_ge_16
    s_waitcnt lgkmcnt(0)
    v_mfma_f32_32x32x16_bf16 v[144:159], v[32:35], v[160:163], v[112:127]
    v_add_u32 v20, s56, v1
    s_add_u32 s56, s56, 16384
    s_cmp_ge_u32 s56, 147456
    s_cselect_b32 s56, 0, s56
    ds_read_b128 v[48:51], v21 offset:4096
    ds_read_b128 v[52:55], v21 offset:5120
    ds_read_b128 v[56:59], v21 offset:6144
    ds_read_b128 v[60:63], v21 offset:7168
    v_mfma_f32_32x32x16_bf16 v[144:159], v[36:39], v[164:167], v[144:159]
    v_exp_f32 v128, v128
    v_exp_f32 v129, v129
    v_add_f32 v24, v24, v128
    v_cvt_pk_bf16_f32 v96, v128, v129
    v_exp_f32 v130, v130
    v_add_f32 v25, v25, v129
    v_mfma_f32_32x32x16_bf16 v[144:159], v[40:43], v[168:171], v[144:159]
    v_exp_f32 v131, v131
    v_add_f32 v26, v26, v130
    v_cvt_pk_bf16_f32 v97, v130, v131
    v_exp_f32 v132, v132
    v_add_f32 v27, v27, v131
    v_exp_f32 v133, v133
    v_add_f32 v24, v24, v132
    v_mfma_f32_32x32x16_bf16 v[144:159], v[44:47], v[172:175], v[144:159]
    v_cvt_pk_bf16_f32 v98, v132, v133
    v_exp_f32 v134, v134
    v_add_f32 v25, v25, v133
    v_exp_f32 v135, v135
    v_add_f32 v26, v26, v134
    v_cvt_pk_bf16_f32 v99, v134, v135
    v_exp_f32 v136, v136
    s_waitcnt lgkmcnt(0)
    v_mfma_f32_32x32x16_bf16 v[144:159], v[48:51], v[176:179], v[144:159]
    ds_read_b128 v[32:35], v20 offset:0
    ds_read_b128 v[36:39], v20 offset:1024
    ds_read_b128 v[40:43], v20 offset:2048
    ds_read_b128 v[44:47], v20 offset:3072
    v_mfma_f32_32x32x16_bf16 v[144:159], v[52:55], v[180:183], v[144:159]
    v_add_f32 v27, v27, v135
    v_exp_f32 v137, v137
    v_add_f32 v24, v24, v136
    v_cvt_pk_bf16_f32 v100, v136, v137
    v_exp_f32 v138, v138
    v_add_f32 v25, v25, v137
    v_mfma_f32_32x32x16_bf16 v[144:159], v[56:59], v[184:187], v[144:159]
    v_exp_f32 v139, v139
    v_add_f32 v26, v26, v138
    v_cvt_pk_bf16_f32 v101, v138, v139
    v_exp_f32 v140, v140
    v_add_f32 v27, v27, v139
    v_exp_f32 v141, v141
    v_add_f32 v24, v24, v140
    v_mfma_f32_32x32x16_bf16 v[144:159], v[60:63], v[188:191], v[144:159]
    v_cvt_pk_bf16_f32 v102, v140, v141
    v_exp_f32 v142, v142
    v_add_f32 v25, v25, v141
    v_exp_f32 v143, v143
    v_add_f32 v26, v26, v142
    v_cvt_pk_bf16_f32 v103, v142, v143
    v_add_f32 v27, v27, v143
    s_branch b_next_13
b_ge_16:
    s_cmp_eq_u32 s58, s49
    s_cbranch_scc0 b_pv_17
    s_cmp_lt_u32 s58, 2
    s_cbranch_scc1 b_sm_19
    ds_read_b128 v[32:35], v21 offset:8192
    ds_read_b128 v[36:39], v21 offset:9216
    ds_read_b128 v[40:43], v21 offset:10240
    ds_read_b128 v[44:47], v21 offset:11264
    s_waitcnt lgkmcnt(0)
    v_mfma_f32_32x32x16_bf16 v[192:207], v[32:35], v[104:107], v[192:207]
    v_add_u32 v20, s56, v1
    s_add_u32 s56, s56, 16384
    s_cmp_ge_u32 s56, 147456
    s_cselect_b32 s56, 0, s56
    ds_read_b128 v[48:51], v21 offset:12288
    ds_read_b128 v[52:55], v21 offset:13312
    ds_read_b128 v[56:59], v21 offset:14336
    ds_read_b128 v[60:63], v21 offset:15360
    v_mfma_f32_32x32x16_bf16 v[208:223], v[36:39], v[104:107], v[208:223]
    v_exp_f32 v128, v128
    v_exp_f32 v129, v129
    v_add_f32 v24, v24, v128
    v_cvt_pk_bf16_f32 v96, v128, v129
    v_exp_f32 v130, v130
    v_add_f32 v25, v25, v129
    v_mfma_f32_32x32x16_bf16 v[224:239], v[40:43], v[104:107], v[224:239]
    v_exp_f32 v131, v131
    v_add_f32 v26, v26, v130
    v_cvt_pk_bf16_f32 v97, v130, v131
    v_exp_f32 v132, v132
    v_add_f32 v27, v27, v131
    v_exp_f32 v133, v133
    v_add_f32 v24, v24, v132
    v_mfma_f32_32x32x16_bf16 v[240:255], v[44:47], v[104:107], v[240:255]
    v_cvt_pk_bf16_f32 v98, v132, v133
    v_exp_f32 v134, v134
    v_add_f32 v25, v25, v133
    v_exp_f32 v135, v135
    v_add_f32 v26, v26, v134
    v_cvt_pk_bf16_f32 v99, v134, v135
    v_exp_f32 v136, v136
    s_waitcnt lgkmcnt(0)
    v_mfma_f32_32x32x16_bf16 v[192:207], v[48:51], v[108:111], v[192:207]
    v_mfma_f32_32x32x16_bf16 v[208:223], v[52:55], v[108:111], v[208:223]
    v_add_f32 v27, v27, v135
    v_exp_f32 v137, v137
    v_add_f32 v24, v24, v136
    v_cvt_pk_bf16_f32 v100, v136, v137
    v_exp_f32 v138, v138
    v_add_f32 v25, v25, v137
    v_mfma_f32_32x32x16_bf16 v[224:239], v[56:59], v[108:111], v[224:239]
    v_exp_f32 v139, v139
    v_add_f32 v26, v26, v138
    v_cvt_pk_bf16_f32 v101, v138, v139
    v_exp_f32 v140, v140
    v_add_f32 v27, v27, v139
    v_exp_f32 v141, v141
    v_add_f32 v24, v24, v140
    v_mfma_f32_32x32x16_bf16 v[240:255], v[60:63], v[108:111], v[240:255]
    v_cvt_pk_bf16_f32 v102, v140, v141
    v_exp_f32 v142, v142
    v_add_f32 v25, v25, v141
    v_exp_f32 v143, v143
    v_add_f32 v26, v26, v142
    v_cvt_pk_bf16_f32 v103, v142, v143
    v_add_f32 v27, v27, v143
    s_branch b_next_13
b_sm_19:
    v_add_u32 v20, s56, v1
    s_add_u32 s56, s56, 16384
    s_cmp_ge_u32 s56, 147456
    s_cselect_b32 s56, 0, s56
    v_exp_f32 v128, v128
    v_exp_f32 v129, v129
    v_add_f32 v24, v24, v128
    v_cvt_pk_bf16_f32 v96, v128, v129
    v_exp_f32 v130, v130
    v_add_f32 v25, v25, v129
    v_exp_f32 v131, v131
    v_add_f32 v26, v26, v130
    v_cvt_pk_bf16_f32 v97, v130, v131
    v_exp_f32 v132, v132
    v_add_f32 v27, v27, v131
    v_exp_f32 v133, v133
    v_add_f32 v24, v24, v132
    v_cvt_pk_bf16_f32 v98, v132, v133
    v_exp_f32 v134, v134
    v_add_f32 v25, v25, v133
    v_exp_f32 v135, v135
    v_add_f32 v26, v26, v134
    v_cvt_pk_bf16_f32 v99, v134, v135
    v_exp_f32 v136, v136
    v_add_f32 v27, v27, v135
    v_exp_f32 v137, v137
    v_add_f32 v24, v24, v136
    v_cvt_pk_bf16_f32 v100, v136, v137
    v_exp_f32 v138, v138
    v_add_f32 v25, v25, v137
    v_exp_f32 v139, v139
    v_add_f32 v26, v26, v138
    v_cvt_pk_bf16_f32 v101, v138, v139
    v_exp_f32 v140, v140
    v_add_f32 v27, v27, v139
    v_exp_f32 v141, v141
    v_add_f32 v24, v24, v140
    v_cvt_pk_bf16_f32 v102, v140, v141
    v_exp_f32 v142, v142
    v_add_f32 v25, v25, v141
    v_exp_f32 v143, v143
    v_add_f32 v26, v26, v142
    v_cvt_pk_bf16_f32 v103, v142, v143
    v_add_f32 v27, v27, v143
    s_branch b_next_13
b_pv_17:
    s_add_u32 s28, s49, 1
    s_cmp_eq_u32 s58, s28
    s_cbranch_scc0 b_none_18
    s_nop 1
    ds_read_b128 v[32:35], v21 offset:8192
    ds_read_b128 v[36:39], v21 offset:9216
    ds_read_b128 v[40:43], v21 offset:10240
    ds_read_b128 v[44:47], v21 offset:11264
    s_waitcnt lgkmcnt(0)
    v_mfma_f32_32x32x16_bf16 v[192:207], v[32:35], v[104:107], v[192:207]
    v_add_u32 v20, s56, v1
    s_add_u32 s56, s56, 16384
    s_cmp_ge_u32 s56, 147456
    s_cselect_b32 s56, 0, s56
    ds_read_b128 v[48:51], v21 offset:12288
    ds_read_b128 v[52:55], v21 offset:13312
    ds_read_b128 v[56:59], v21 offset:14336
    ds_read_b128 v[60:63], v21 offset:15360
    v_mfma_f32_32x32x16_bf16 v[208:223], v[36:39], v[104:107], v[208:223]
    v_mfma_f32_32x32x16_bf16 v[224:239], v[40:43], v[104:107], v[224:239]
    v_mfma_f32_32x32x16_bf16 v[240:255], v[44:47], v[104:107], v[240:255]
    s_waitcnt lgkmcnt(0)
    v_mfma_f32_32x32x16_bf16 v[192:207], v[48:51], v[108:111], v[192:207]
    v_mfma_f32_32x32x16_bf16 v[208:223], v[52:55], v[108:111], v[208:223]
    v_mfma_f32_32x32x16_bf16 v[224:239], v[56:59], v[108:111], v[224:239]
    v_mfma_f32_32x32x16_bf16 v[240:255], v[60:63], v[108:111], v[240:255]
    s_branch b_next_13
b_none_18:
    v_add_u32 v20, s56, v1
    s_add_u32 s56, s56, 16384
    s_cmp_ge_u32 s56, 147456
    s_cselect_b32 s56, 0, s56
b_next_13:
    s_add_u32 s58, s58, 1
    s_add_u32 s28, s50, 2
    s_cmp_lt_u32 s58, s28
    s_cbranch_scc1 b_loop
    s_nop 7
    v_add_f32 v24, v24, v25
    v_add_f32 v26, v26, v27
    v_add_f32 v24, v24, v26
    v_mov_b32 v19, v24
    s_nop 1
    v_permlane32_swap_b32 v19, v24
    s_nop 1
    v_add_f32 v24, v24, v19
    v_rcp_f32 v26, v24
    v_mov_b32 v19, 0
    v_fma_f32 v19, v192, 0, v19
    v_fma_f32 v19, v193, 0, v19
    v_fma_f32 v19, v194, 0, v19
    v_fma_f32 v19, v195, 0, v19
    v_fma_f32 v19, v196, 0, v19
    v_fma_f32 v19, v197, 0, v19
    v_fma_f32 v19, v198, 0, v19
    v_fma_f32 v19, v199, 0, v19
    v_fma_f32 v19, v200, 0, v19
    v_fma_f32 v19, v201, 0, v19
    v_fma_f32 v19, v202, 0, v19
    v_fma_f32 v19, v203, 0, v19
    v_fma_f32 v19, v204, 0, v19
    v_fma_f32 v19, v205, 0, v19
    v_fma_f32 v19, v206, 0, v19
    v_fma_f32 v19, v207, 0, v19
    v_fma_f32 v19, v208, 0, v19
    v_fma_f32 v19, v209, 0, v19
    v_fma_f32 v19, v210, 0, v19
    v_fma_f32 v19, v211, 0, v19
    v_fma_f32 v19, v212, 0, v19
    v_fma_f32 v19, v213, 0, v19
    v_fma_f32 v19, v214, 0, v19
    v_fma_f32 v19, v215, 0, v19
    v_fma_f32 v19, v216, 0, v19
    v_fma_f32 v19, v217, 0, v19
    v_fma_f32 v19, v218, 0, v19
    v_fma_f32 v19, v219, 0, v19
    v_fma_f32 v19, v220, 0, v19
    v_fma_f32 v19, v221, 0, v19
    v_fma_f32 v19, v222, 0, v19
    v_fma_f32 v19, v223, 0, v19
    v_fma_f32 v19, v224, 0, v19
    v_fma_f32 v19, v225, 0, v19
    v_fma_f32 v19, v226, 0, v19
    v_fma_f32 v19, v227, 0, v19
    v_fma_f32 v19, v228, 0, v19
    v_fma_f32 v19, v229, 0, v19
    v_fma_f32 v19, v230, 0, v19
    v_fma_f32 v19, v231, 0, v19
    v_fma_f32 v19, v232, 0, v19
    v_fma_f32 v19, v233, 0, v19
    v_fma_f32 v19, v234, 0, v19
    v_fma_f32 v19, v235, 0, v19
    v_fma_f32 v19, v236, 0, v19
    v_fma_f32 v19, v237, 0, v19
    v_fma_f32 v19, v238, 0, v19
    v_fma_f32 v19, v239, 0, v19
    v_fma_f32 v19, v240, 0, v19
    v_fma_f32 v19, v241, 0, v19
    v_fma_f32 v19, v242, 0, v19
    v_fma_f32 v19, v243, 0, v19
    v_fma_f32 v19, v244, 0, v19
    v_fma_f32 v19, v245, 0, v19
    v_fma_f32 v19, v246, 0, v19
    v_fma_f32 v19, v247, 0, v19
    v_fma_f32 v19, v248, 0, v19
    v_fma_f32 v19, v249, 0, v19
    v_fma_f32 v19, v250, 0, v19
    v_fma_f32 v19, v251, 0, v19
    v_fma_f32 v19, v252, 0, v19
    v_fma_f32 v19, v253, 0, v19
    v_fma_f32 v19, v254, 0, v19
    v_fma_f32 v19, v255, 0, v19
    s_mov_b32 s28, 0x5d800000
    v_cmp_nle_f32 vcc, v24, s28
    v_cmp_u_f32 s[62:63], v19, v19
    s_or_b64 s[62:63], s[62:63], vcc
    s_cmp_lg_u64 s[62:63], 0
    s_cselect_b32 s28, 1, 0
    v_mov_b32 v19, s28
    s_lshl_b32 s29, s3, 2
    s_lshl_b32 s40, s46, 4
    s_add_u32 s29, s29, 155648
    v_mov_b32 v22, s29
    ds_write_b32 v22, v19
    s_waitcnt lgkmcnt(0)
    s_barrier
    v_mov_b32 v32, 155648
    ds_read_b128 v[34:37], v32
    s_waitcnt lgkmcnt(0)
    v_or3_b32 v32, v34, v35, v36
    v_or_b32 v32, v32, v37
    s_nop 0
    v_readfirstlane_b32 s28, v32
    s_cmp_eq_u32 s28, 0
    s_cbranch_scc1 b_ok
    s_cmp_lg_u32 s60, 0
    s_cbranch_scc1 b_ok
    s_mov_b32 s60, 1
    s_mov_b32 s58, 0
    s_mov_b32 s61, 0
    v_mov_b32 v22, 0xff800000
b_maxloop:
    s_barrier
    s_cmp_ge_u32 s58, s49
    s_cbranch_scc1 b_maxskip
    ds_read_b128 v[32:35], v1 offset:0
    ds_read_b128 v[36:39], v1 offset:1024
    ds_read_b128 v[40:43], v1 offset:2048
    ds_read_b128 v[44:47], v1 offset:3072
    ds_read_b128 v[48:51], v1 offset:4096
    ds_read_b128 v[52:55], v1 offset:5120
    ds_read_b128 v[56:59], v1 offset:6144
    ds_read_b128 v[60:63], v1 offset:7168
    s_waitcnt lgkmcnt(0)
    v_mfma_f32_32x32x16_bf16 v[128:143], v[32:35], v[160:163], 0
    v_mfma_f32_32x32x16_bf16 v[128:143], v[36:39], v[164:167], v[128:143]
    v_mfma_f32_32x32x16_bf16 v[128:143], v[40:43], v[168:171], v[128:143]
    v_mfma_f32_32x32x16_bf16 v[128:143], v[44:47], v[172:175], v[128:143]
    v_mfma_f32_32x32x16_bf16 v[128:143], v[48:51], v[176:179], v[128:143]
    v_mfma_f32_32x32x16_bf16 v[128:143], v[52:55], v[180:183], v[128:143]
    v_mfma_f32_32x32x16_bf16 v[128:143], v[56:59], v[184:187], v[128:143]
    v_mfma_f32_32x32x16_bf16 v[128:143], v[60:63], v[188:191], v[128:143]
    s_nop 15
    s_add_u32 s28, s58, 1
    s_cmp_lg_u32 s28, s49
    s_cbranch_scc1 b_maxnomask
    v_mov_b32 v19, 0xff800000
    v_cmp_gt_i32 vcc, 0, v18
    s_nop 1
    v_cndmask_b32 v128, v128, v19, vcc
    v_cmp_gt_i32 vcc, 1, v18
    s_nop 1
    v_cndmask_b32 v129, v129, v19, vcc
    v_cmp_gt_i32 vcc, 2, v18
    s_nop 1
    v_cndmask_b32 v130, v130, v19, vcc
    v_cmp_gt_i32 vcc, 3, v18
    s_nop 1
    v_cndmask_b32 v131, v131, v19, vcc
    v_cmp_gt_i32 vcc, 8, v18
    s_nop 1
    v_cndmask_b32 v132, v132, v19, vcc
    v_cmp_gt_i32 vcc, 9, v18
    s_nop 1
    v_cndmask_b32 v133, v133, v19, vcc
    v_cmp_gt_i32 vcc, 10, v18
    s_nop 1
    v_cndmask_b32 v134, v134, v19, vcc
    v_cmp_gt_i32 vcc, 11, v18
    s_nop 1
    v_cndmask_b32 v135, v135, v19, vcc
    v_cmp_gt_i32 vcc, 16, v18
    s_nop 1
    v_cndmask_b32 v136, v136, v19, vcc
    v_cmp_gt_i32 vcc, 17, v18
    s_nop 1
    v_cndmask_b32 v137, v137, v19, vcc
    v_cmp_gt_i32 vcc, 18, v18
    s_nop 1
    v_cndmask_b32 v138, v138, v19, vcc
    v_cmp_gt_i32 vcc, 19, v18
    s_nop 1
    v_cndmask_b32 v139, v139, v19, vcc
    v_cmp_gt_i32 vcc, 24, v18
    s_nop 1
    v_cndmask_b32 v140, v140, v19, vcc
    v_cmp_gt_i32 vcc, 25, v18
    s_nop 1
    v_cndmask_b32 v141, v141, v19, vcc
    v_cmp_gt_i32 vcc, 26, v18
    s_nop 1
    v_cndmask_b32 v142, v142, v19, vcc
    v_cmp_gt_i32 vcc, 27, v18
    s_nop 1
    v_cndmask_b32 v143, v143, v19, vcc
b_maxnomask:
    v_max3_f32 v22, v22, v128, v129
    v_max3_f32 v22, v22, v130, v131
    v_max3_f32 v22, v22, v132, v133
    v_max3_f32 v22, v22, v134, v135
    v_max3_f32 v22, v22, v136, v137
    v_max3_f32 v22, v22, v138, v139
    v_max3_f32 v22, v22, v140, v141
    v_max3_f32 v22, v22, v142, v143
b_maxskip:
    s_barrier
    s_add_u32 s58, s58, 1
    s_cmp_lt_u32 s58, s50
    s_cbranch_scc1 b_maxloop
    v_mov_b32 v19, v22
    s_nop 1
    v_permlane32_swap_b32 v19, v22
    s_nop 1
    v_max_f32 v22, v22, v19
    v_sub_f32 v112, 0, v22
    v_sub_f32 v113, 0, v22
    v_sub_f32 v114, 0, v22
    v_sub_f32 v115, 0, v22
    v_sub_f32 v116, 0, v22
    v_sub_f32 v117, 0, v22
    v_sub_f32 v118, 0, v22
    v_sub_f32 v119, 0, v22
    v_sub_f32 v120, 0, v22
    v_sub_f32 v121, 0, v22
    v_sub_f32 v122, 0, v22
    v_sub_f32 v123, 0, v22
    v_sub_f32 v124, 0, v22
    v_sub_f32 v125, 0, v22
    v_sub_f32 v126, 0, v22
    v_sub_f32 v127, 0, v22
    s_branch b_task
b_ok:
    s_mov_b32 s60, 0
    s_add_u32 s46, s46, 1
    s_add_u32 s61, s56, 16384
    s_cmp_ge_u32 s61, 147456
    s_cselect_b32 s61, 0, s61
    s_sub_u32 s47, 15, s7
    s_cmp_eq_u32 s46, 0
    s_cselect_b32 s47, s47, s7
    s_lshl_b32 s50, s47, 2
    s_add_u32 s50, s50, 4
    v_mul_f32 v192, v26, v192
    v_mul_f32 v193, v26, v193
    v_mul_f32 v194, v26, v194
    v_mul_f32 v195, v26, v195
    v_mul_f32 v196, v26, v196
    v_mul_f32 v197, v26, v197
    v_mul_f32 v198, v26, v198
    v_mul_f32 v199, v26, v199
    v_mul_f32 v200, v26, v200
    v_mul_f32 v201, v26, v201
    v_mul_f32 v202, v26, v202
    v_mul_f32 v203, v26, v203
    v_mul_f32 v204, v26, v204
    v_mul_f32 v205, v26, v205
    v_mul_f32 v206, v26, v206
    v_mul_f32 v207, v26, v207
    v_mul_f32 v208, v26, v208
    v_mul_f32 v209, v26, v209
    v_mul_f32 v210, v26, v210
    v_mul_f32 v211, v26, v211
    v_mul_f32 v212, v26, v212
    v_mul_f32 v213, v26, v213
    v_mul_f32 v214, v26, v214
    v_mul_f32 v215, v26, v215
    v_mul_f32 v216, v26, v216
    v_mul_f32 v217, v26, v217
    v_mul_f32 v218, v26, v218
    v_mul_f32 v219, v26, v219
    v_mul_f32 v220, v26, v220
    v_mul_f32 v221, v26, v221
    v_mul_f32 v222, v26, v222
    v_mul_f32 v223, v26, v223
    v_mul_f32 v224, v26, v224
    v_mul_f32 v225, v26, v225
    v_mul_f32 v226, v26, v226
    v_mul_f32 v227, v26, v227
    v_mul_f32 v228, v26, v228
    v_mul_f32 v229, v26, v229
    v_mul_f32 v230, v26, v230
    v_mul_f32 v231, v26, v231
    v_mul_f32 v232, v26, v232
    v_mul_f32 v233, v26, v233
    v_mul_f32 v234, v26, v234
    v_mul_f32 v235, v26, v235
    v_mul_f32 v236, v26, v236
    v_mul_f32 v237, v26, v237
    v_mul_f32 v238, v26, v238
    v_mul_f32 v239, v26, v239
    v_mul_f32 v240, v26, v240
    v_mul_f32 v241, v26, v241
    v_mul_f32 v242, v26, v242
    v_mul_f32 v243, v26, v243
    v_mul_f32 v244, v26, v244
    v_mul_f32 v245, v26, v245
    v_mul_f32 v246, v26, v246
    v_mul_f32 v247, v26, v247
    v_mul_f32 v248, v26, v248
    v_mul_f32 v249, v26, v249
    v_mul_f32 v250, v26, v250
    v_mul_f32 v251, v26, v251
    v_mul_f32 v252, v26, v252
    v_mul_f32 v253, v26, v253
    v_mul_f32 v254, v26, v254
    v_mul_f32 v255, v26, v255
    s_lshr_b32 s28, s48, 5
    s_mul_i32 s28, s28, 294912
    s_lshl_b32 s29, s6, 13
    s_add_u32 s28, s28, s29
    s_add_u32 s28, s28, 34603008
    s_add_u32 s29, s28, 4096
    v_cvt_pk_bf16_f32 v32, v192, v193
    v_cvt_pk_bf16_f32 v33, v194, v195
    v_cvt_pk_bf16_f32 v34, v196, v197
    v_cvt_pk_bf16_f32 v35, v198, v199
    buffer_store_dwordx4 v[32:35], v1, s[20:23], s28 offen offset:0 sc1
    v_cvt_pk_bf16_f32 v36, v200, v201
    v_cvt_pk_bf16_f32 v37, v202, v203
    v_cvt_pk_bf16_f32 v38, v204, v205
    v_cvt_pk_bf16_f32 v39, v206, v207
    buffer_store_dwordx4 v[36:39], v1, s[20:23], s28 offen offset:1024 sc1
    v_cvt_pk_bf16_f32 v40, v208, v209
    v_cvt_pk_bf16_f32 v41, v210, v211
    v_cvt_pk_bf16_f32 v42, v212, v213
    v_cvt_pk_bf16_f32 v43, v214, v215
    buffer_store_dwordx4 v[40:43], v1, s[20:23], s28 offen offset:2048 sc1
    v_cvt_pk_bf16_f32 v44, v216, v217
    v_cvt_pk_bf16_f32 v45, v218, v219
    v_cvt_pk_bf16_f32 v46, v220, v221
    v_cvt_pk_bf16_f32 v47, v222, v223
    buffer_store_dwordx4 v[44:47], v1, s[20:23], s28 offen offset:3072 sc1
    v_cvt_pk_bf16_f32 v48, v224, v225
    v_cvt_pk_bf16_f32 v49, v226, v227
    v_cvt_pk_bf16_f32 v50, v228, v229
    v_cvt_pk_bf16_f32 v51, v230, v231
    buffer_store_dwordx4 v[48:51], v1, s[20:23], s29 offen offset:0 sc1
    v_cvt_pk_bf16_f32 v52, v232, v233
    v_cvt_pk_bf16_f32 v53, v234, v235
    v_cvt_pk_bf16_f32 v54, v236, v237
    v_cvt_pk_bf16_f32 v55, v238, v239
    buffer_store_dwordx4 v[52:55], v1, s[20:23], s29 offen offset:1024 sc1
    v_cvt_pk_bf16_f32 v56, v240, v241
    v_cvt_pk_bf16_f32 v57, v242, v243
    v_cvt_pk_bf16_f32 v58, v244, v245
    v_cvt_pk_bf16_f32 v59, v246, v247
    buffer_store_dwordx4 v[56:59], v1, s[20:23], s29 offen offset:2048 sc1
    v_cvt_pk_bf16_f32 v60, v248, v249
    v_cvt_pk_bf16_f32 v61, v250, v251
    v_cvt_pk_bf16_f32 v62, v252, v253
    v_cvt_pk_bf16_f32 v63, v254, v255
    buffer_store_dwordx4 v[60:63], v1, s[20:23], s29 offen offset:3072 sc1
    v_mov_b32 v160, v64
    v_mov_b32 v161, v65
    v_mov_b32 v162, v66
    v_mov_b32 v163, v67
    v_mov_b32 v164, v68
    v_mov_b32 v165, v69
    v_mov_b32 v166, v70
    v_mov_b32 v167, v71
    v_mov_b32 v168, v72
    v_mov_b32 v169, v73
    v_mov_b32 v170, v74
    v_mov_b32 v171, v75
    v_mov_b32 v172, v76
    v_mov_b32 v173, v77
    v_mov_b32 v174, v78
    v_mov_b32 v175, v79
    v_mov_b32 v176, v80
    v_mov_b32 v177, v81
    v_mov_b32 v178, v82
    v_mov_b32 v179, v83
    v_mov_b32 v180, v84
    v_mov_b32 v181, v85
    v_mov_b32 v182, v86
    v_mov_b32 v183, v87
    v_mov_b32 v184, v88
    v_mov_b32 v185, v89
    v_mov_b32 v186, v90
    v_mov_b32 v187, v91
    v_mov_b32 v188, v92
    v_mov_b32 v189, v93
    v_mov_b32 v190, v94
    v_mov_b32 v191, v95
    s_cmp_lt_u32 s46, 2
    s_cbranch_scc1 b_task
    s_waitcnt vmcnt(0)
    s_mov_b32 s49, s7
    s_branch p3_g
k1_side:
    s_and_b32 s28, s2, 7
    s_lshl_b32 s28, s28, 1
    s_lshr_b32 s29, s2, 7
    s_add_u32 s66, s28, s29
    s_lshr_b32 s67, s2, 3
    s_and_b32 s67, s67, 15
    s_waitcnt vmcnt(0)
    s_mov_b32 s46, 0
    s_mov_b32 s44, 0
    s_sub_u32 s45, s3, 4
    v_and_b32 v4, 31, v0
    v_lshrrev_b32 v5, 5, v0
    v_lshlrev_b32 v12, 10, v4
    v_lshl_add_u32 v12, v5, 4, v12
    s_lshl_b32 s28, s66, 2
    s_add_u32 s28, s28, s45
    s_lshl_b32 s48, s28, 15
    s_lshl_b32 s49, s66, 2
    s_add_u32 s49, s49, 3
    s_lshl_b32 s49, s49, 15
    v_bfe_u32 v6, v0, 2, 2
    v_lshl_add_u32 v13, v5, 3, v6
    v_lshlrev_b32 v13, 6, v13
    v_lshl_add_u32 v14, v5, 2, v6
    v_lshlrev_b32 v14, 6, v14
    v_bfe_u32 v6, v0, 4, 1
    v_lshlrev_b32 v6, 5, v6
    v_and_b32 v7, 3, v0
    v_lshl_add_u32 v6, v7, 3, v6
    v_add_u32 v13, v6, v13
    v_add_u32 v13, 147456, v13
    v_add_u32 v14, v6, v14
    s_lshl_b32 s28, s45, 10
    s_add_u32 s51, s28, 155904
    v_add_u32 v14, s51, v14
    v_lshrrev_b32 v15, 2, v0
    v_lshlrev_b32 v15, 10, v15
    v_lshl_add_u32 v15, v7, 4, v15
    s_mov_b32 s92, s58
    s_mov_b32 s93, s59
    s_mov_b32 s94, 524288
    s_mov_b32 s95, 0x00020000
    s_mul_i32 s52, s2, 18
    s_mul_i32 s28, s45, 6
    s_add_u32 s52, s52, s28
    s_mov_b32 s19, 0x00020000
    s_sub_u32 s47, 15, s7
    s_cmp_eq_u32 s46, 0
    s_cselect_b32 s47, s47, s7
    s_lshl_b32 s50, s47, 2
    s_add_u32 s50, s50, 4
    s_cmp_lg_u32 s3, 5
    s_cbranch_scc1 sw_ni
    v_mov_b32 v3, 0
    s_mov_b32 s41, 0
sw_ip:
    buffer_load_dword v2, v3, s[80:83], 0 offen sc1
    s_waitcnt vmcnt(0)
    v_readfirstlane_b32 s29, v2
    s_and_b32 s29, s29, 1
    s_cbranch_scc1 sw_ipd
    s_sleep 8
    s_add_u32 s41, s41, 1
    s_cmp_lt_u32 s41, 0x100000
    s_cbranch_scc1 sw_ip
sw_ipd:
sw_ni:
    s_barrier
    buffer_load_dwordx4 v[64:67], v12, s[76:79], s48 offen offset:0
    buffer_load_dwordx4 v[68:71], v12, s[76:79], s48 offen offset:32
    buffer_load_dwordx4 v[72:75], v12, s[76:79], s48 offen offset:64
    buffer_load_dwordx4 v[76:79], v12, s[76:79], s48 offen offset:96
    s_cmp_lg_u32 s3, 4
    s_cbranch_scc1 sw_n3_20
    buffer_load_dwordx4 v[80:83], v12, s[76:79], s49 offen offset:0
    buffer_load_dwordx4 v[84:87], v12, s[76:79], s49 offen offset:32
    buffer_load_dwordx4 v[88:91], v12, s[76:79], s49 offen offset:64
    buffer_load_dwordx4 v[92:95], v12, s[76:79], s49 offen offset:96
sw_n3_20:
    s_cmp_lg_u32 s3, 6
    s_cbranch_scc1 sw_n4_21
    s_mov_b32 m0, 147456
    s_lshl_b32 s29, s67, 6
    s_add_u32 s28, s29, 0
    buffer_load_dwordx4 v15, s[92:95], s28 offen offset:0 lds
    s_add_u32 s28, s29, 15360
    buffer_load_dwordx4 v15, s[92:95], s28 offen offset:1024 lds
    s_add_u32 s28, s29, 30720
    buffer_load_dwordx4 v15, s[92:95], s28 offen offset:2048 lds
    s_add_u32 s28, s29, 46080
    buffer_load_dwordx4 v15, s[92:95], s28 offen offset:3072 lds
sw_n4_21:
    s_lshr_b32 s28, s52, 4
    s_and_b32 s29, s52, 15
    s_lshl_b32 s29, s29, 6
    s_cmp_lt_u32 s28, 256
    s_cselect_b32 s16, s56, s60
    s_cselect_b32 s17, s57, s61
    s_cselect_b32 s18, 4194304, s94
    s_and_b32 s28, s28, 255
    s_lshl_b32 s28, s28, 14
    s_add_u32 s28, s28, s29
    s_mov_b32 m0, s51
    s_nop 0
    buffer_load_dwordx4 v15, s[16:19], s28 offen lds
    s_cmp_lg_u32 s3, 6
    s_cbranch_scc1 sw_n5_22
    s_waitcnt vmcnt(0)
sw_n5_22:
    s_barrier
    s_waitcnt vmcnt(0)
    ds_read_b64_tr_b16 v[96:97], v13 offset:0
    ds_read_b64_tr_b16 v[98:99], v13 offset:256
    ds_read_b64_tr_b16 v[100:101], v13 offset:1024
    ds_read_b64_tr_b16 v[102:103], v13 offset:1280
    ds_read_b64_tr_b16 v[104:105], v13 offset:2048
    ds_read_b64_tr_b16 v[106:107], v13 offset:2304
    ds_read_b64_tr_b16 v[108:109], v13 offset:3072
    ds_read_b64_tr_b16 v[110:111], v13 offset:3328
    ds_read_b64_tr_b16 v[112:113], v14
    ds_read_b64_tr_b16 v[114:115], v14 offset:512
    s_waitcnt lgkmcnt(0)
    s_lshl_b32 s28, s52, 10
    s_add_u32 s28, s28, 67108864
    buffer_store_dwordx4 v[112:115], v1, s[20:23], s28 offen sc1
    s_add_u32 s52, s52, 1
    v_mfma_f32_32x32x16_bf16 v[128:143], v[96:99], v[64:67], 0
    v_mfma_f32_32x32x16_bf16 v[128:143], v[100:103], v[68:71], v[128:143]
    v_mfma_f32_32x32x16_bf16 v[128:143], v[104:107], v[72:75], v[128:143]
    v_mfma_f32_32x32x16_bf16 v[128:143], v[108:111], v[76:79], v[128:143]
    s_cmp_lg_u32 s3, 4
    s_cbranch_scc1 sw_n2_23
    v_mfma_f32_32x32x16_bf16 v[144:159], v[96:99], v[80:83], 0
    v_mfma_f32_32x32x16_bf16 v[144:159], v[100:103], v[84:87], v[144:159]
    v_mfma_f32_32x32x16_bf16 v[144:159], v[104:107], v[88:91], v[144:159]
    v_mfma_f32_32x32x16_bf16 v[144:159], v[108:111], v[92:95], v[144:159]
sw_n2_23:
    buffer_load_dwordx4 v[64:67], v12, s[76:79], s48 offen offset:128
    buffer_load_dwordx4 v[68:71], v12, s[76:79], s48 offen offset:160
    buffer_load_dwordx4 v[72:75], v12, s[76:79], s48 offen offset:192
    buffer_load_dwordx4 v[76:79], v12, s[76:79], s48 offen offset:224
    s_cmp_lg_u32 s3, 4
    s_cbranch_scc1 sw_n3_24
    buffer_load_dwordx4 v[80:83], v12, s[76:79], s49 offen offset:128
    buffer_load_dwordx4 v[84:87], v12, s[76:79], s49 offen offset:160
    buffer_load_dwordx4 v[88:91], v12, s[76:79], s49 offen offset:192
    buffer_load_dwordx4 v[92:95], v12, s[76:79], s49 offen offset:224
sw_n3_24:
    s_cmp_lg_u32 s3, 6
    s_cbranch_scc1 sw_n4_25
    s_mov_b32 m0, 151552
    s_lshl_b32 s29, s67, 6
    s_add_u32 s28, s29, 65536
    buffer_load_dwordx4 v15, s[92:95], s28 offen offset:0 lds
    s_add_u32 s28, s29, 80896
    buffer_load_dwordx4 v15, s[92:95], s28 offen offset:1024 lds
    s_add_u32 s28, s29, 96256
    buffer_load_dwordx4 v15, s[92:95], s28 offen offset:2048 lds
    s_add_u32 s28, s29, 111616
    buffer_load_dwordx4 v15, s[92:95], s28 offen offset:3072 lds
sw_n4_25:
    s_lshr_b32 s28, s52, 4
    s_and_b32 s29, s52, 15
    s_lshl_b32 s29, s29, 6
    s_cmp_lt_u32 s28, 256
    s_cselect_b32 s16, s56, s60
    s_cselect_b32 s17, s57, s61
    s_cselect_b32 s18, 4194304, s94
    s_and_b32 s28, s28, 255
    s_lshl_b32 s28, s28, 14
    s_add_u32 s28, s28, s29
    s_mov_b32 m0, s51
    s_nop 0
    buffer_load_dwordx4 v15, s[16:19], s28 offen lds
    s_cmp_lg_u32 s3, 6
    s_cbranch_scc1 sw_n5_26
    s_waitcnt vmcnt(0)
sw_n5_26:
    s_barrier
    s_waitcnt vmcnt(0)
    ds_read_b64_tr_b16 v[96:97], v13 offset:4096
    ds_read_b64_tr_b16 v[98:99], v13 offset:4352
    ds_read_b64_tr_b16 v[100:101], v13 offset:5120
    ds_read_b64_tr_b16 v[102:103], v13 offset:5376
    ds_read_b64_tr_b16 v[104:105], v13 offset:6144
    ds_read_b64_tr_b16 v[106:107], v13 offset:6400
    ds_read_b64_tr_b16 v[108:109], v13 offset:7168
    ds_read_b64_tr_b16 v[110:111], v13 offset:7424
    ds_read_b64_tr_b16 v[112:113], v14
    ds_read_b64_tr_b16 v[114:115], v14 offset:512
    s_waitcnt lgkmcnt(0)
    s_lshl_b32 s28, s52, 10
    s_add_u32 s28, s28, 67108864
    buffer_store_dwordx4 v[112:115], v1, s[20:23], s28 offen sc1
    s_add_u32 s52, s52, 1
    v_mfma_f32_32x32x16_bf16 v[128:143], v[96:99], v[64:67], v[128:143]
    v_mfma_f32_32x32x16_bf16 v[128:143], v[100:103], v[68:71], v[128:143]
    v_mfma_f32_32x32x16_bf16 v[128:143], v[104:107], v[72:75], v[128:143]
    v_mfma_f32_32x32x16_bf16 v[128:143], v[108:111], v[76:79], v[128:143]
    s_cmp_lg_u32 s3, 4
    s_cbranch_scc1 sw_n2_27
    v_mfma_f32_32x32x16_bf16 v[144:159], v[96:99], v[80:83], v[144:159]
    v_mfma_f32_32x32x16_bf16 v[144:159], v[100:103], v[84:87], v[144:159]
    v_mfma_f32_32x32x16_bf16 v[144:159], v[104:107], v[88:91], v[144:159]
    v_mfma_f32_32x32x16_bf16 v[144:159], v[108:111], v[92:95], v[144:159]
sw_n2_27:
    buffer_load_dwordx4 v[64:67], v12, s[76:79], s48 offen offset:256
    buffer_load_dwordx4 v[68:71], v12, s[76:79], s48 offen offset:288
    buffer_load_dwordx4 v[72:75], v12, s[76:79], s48 offen offset:320
    buffer_load_dwordx4 v[76:79], v12, s[76:79], s48 offen offset:352
    s_cmp_lg_u32 s3, 4
    s_cbranch_scc1 sw_n3_28
    buffer_load_dwordx4 v[80:83], v12, s[76:79], s49 offen offset:256
    buffer_load_dwordx4 v[84:87], v12, s[76:79], s49 offen offset:288
    buffer_load_dwordx4 v[88:91], v12, s[76:79], s49 offen offset:320
    buffer_load_dwordx4 v[92:95], v12, s[76:79], s49 offen offset:352
sw_n3_28:
    s_cmp_lg_u32 s3, 6
    s_cbranch_scc1 sw_n4_29
    s_mov_b32 m0, 147456
    s_lshl_b32 s29, s67, 6
    s_add_u32 s28, s29, 131072
    buffer_load_dwordx4 v15, s[92:95], s28 offen offset:0 lds
    s_add_u32 s28, s29, 146432
    buffer_load_dwordx4 v15, s[92:95], s28 offen offset:1024 lds
    s_add_u32 s28, s29, 161792
    buffer_load_dwordx4 v15, s[92:95], s28 offen offset:2048 lds
    s_add_u32 s28, s29, 177152
    buffer_load_dwordx4 v15, s[92:95], s28 offen offset:3072 lds
sw_n4_29:
    s_lshr_b32 s28, s52, 4
    s_and_b32 s29, s52, 15
    s_lshl_b32 s29, s29, 6
    s_cmp_lt_u32 s28, 256
    s_cselect_b32 s16, s56, s60
    s_cselect_b32 s17, s57, s61
    s_cselect_b32 s18, 4194304, s94
    s_and_b32 s28, s28, 255
    s_lshl_b32 s28, s28, 14
    s_add_u32 s28, s28, s29
    s_mov_b32 m0, s51
    s_nop 0
    buffer_load_dwordx4 v15, s[16:19], s28 offen lds
    s_cmp_lg_u32 s3, 6
    s_cbranch_scc1 sw_n5_30
    s_waitcnt vmcnt(0)
sw_n5_30:
    s_barrier
    s_waitcnt vmcnt(0)
    ds_read_b64_tr_b16 v[96:97], v13 offset:0
    ds_read_b64_tr_b16 v[98:99], v13 offset:256
    ds_read_b64_tr_b16 v[100:101], v13 offset:1024
    ds_read_b64_tr_b16 v[102:103], v13 offset:1280
    ds_read_b64_tr_b16 v[104:105], v13 offset:2048
    ds_read_b64_tr_b16 v[106:107], v13 offset:2304
    ds_read_b64_tr_b16 v[108:109], v13 offset:3072
    ds_read_b64_tr_b16 v[110:111], v13 offset:3328
    ds_read_b64_tr_b16 v[112:113], v14
    ds_read_b64_tr_b16 v[114:115], v14 offset:512
    s_waitcnt lgkmcnt(0)
    s_lshl_b32 s28, s52, 10
    s_add_u32 s28, s28, 67108864
    buffer_store_dwordx4 v[112:115], v1, s[20:23], s28 offen sc1
    s_add_u32 s52, s52, 1
    v_mfma_f32_32x32x16_bf16 v[128:143], v[96:99], v[64:67], v[128:143]
    v_mfma_f32_32x32x16_bf16 v[128:143], v[100:103], v[68:71], v[128:143]
    v_mfma_f32_32x32x16_bf16 v[128:143], v[104:107], v[72:75], v[128:143]
    v_mfma_f32_32x32x16_bf16 v[128:143], v[108:111], v[76:79], v[128:143]
    s_cmp_lg_u32 s3, 4
    s_cbranch_scc1 sw_n2_31
    v_mfma_f32_32x32x16_bf16 v[144:159], v[96:99], v[80:83], v[144:159]
    v_mfma_f32_32x32x16_bf16 v[144:159], v[100:103], v[84:87], v[144:159]
    v_mfma_f32_32x32x16_bf16 v[144:159], v[104:107], v[88:91], v[144:159]
    v_mfma_f32_32x32x16_bf16 v[144:159], v[108:111], v[92:95], v[144:159]
sw_n2_31:
    buffer_load_dwordx4 v[64:67], v12, s[76:79], s48 offen offset:384
    buffer_load_dwordx4 v[68:71], v12, s[76:79], s48 offen offset:416
    buffer_load_dwordx4 v[72:75], v12, s[76:79], s48 offen offset:448
    buffer_load_dwordx4 v[76:79], v12, s[76:79], s48 offen offset:480
    s_cmp_lg_u32 s3, 4
    s_cbranch_scc1 sw_n3_32
    buffer_load_dwordx4 v[80:83], v12, s[76:79], s49 offen offset:384
    buffer_load_dwordx4 v[84:87], v12, s[76:79], s49 offen offset:416
    buffer_load_dwordx4 v[88:91], v12, s[76:79], s49 offen offset:448
    buffer_load_dwordx4 v[92:95], v12, s[76:79], s49 offen offset:480
sw_n3_32:
    s_cmp_lg_u32 s3, 6
    s_cbranch_scc1 sw_n4_33
    s_mov_b32 m0, 151552
    s_lshl_b32 s29, s67, 6
    s_add_u32 s28, s29, 196608
    buffer_load_dwordx4 v15, s[92:95], s28 offen offset:0 lds
    s_add_u32 s28, s29, 211968
    buffer_load_dwordx4 v15, s[92:95], s28 offen offset:1024 lds
    s_add_u32 s28, s29, 227328
    buffer_load_dwordx4 v15, s[92:95], s28 offen offset:2048 lds
    s_add_u32 s28, s29, 242688
    buffer_load_dwordx4 v15, s[92:95], s28 offen offset:3072 lds
sw_n4_33:
    s_lshr_b32 s28, s52, 4
    s_and_b32 s29, s52, 15
    s_lshl_b32 s29, s29, 6
    s_cmp_lt_u32 s28, 256
    s_cselect_b32 s16, s56, s60
    s_cselect_b32 s17, s57, s61
    s_cselect_b32 s18, 4194304, s94
    s_and_b32 s28, s28, 255
    s_lshl_b32 s28, s28, 14
    s_add_u32 s28, s28, s29
    s_mov_b32 m0, s51
    s_nop 0
    buffer_load_dwordx4 v15, s[16:19], s28 offen lds
    s_cmp_lg_u32 s3, 6
    s_cbranch_scc1 sw_n5_34
    s_waitcnt vmcnt(0)
sw_n5_34:
    s_barrier
    s_waitcnt vmcnt(0)
    ds_read_b64_tr_b16 v[96:97], v13 offset:4096
    ds_read_b64_tr_b16 v[98:99], v13 offset:4352
    ds_read_b64_tr_b16 v[100:101], v13 offset:5120
    ds_read_b64_tr_b16 v[102:103], v13 offset:5376
    ds_read_b64_tr_b16 v[104:105], v13 offset:6144
    ds_read_b64_tr_b16 v[106:107], v13 offset:6400
    ds_read_b64_tr_b16 v[108:109], v13 offset:7168
    ds_read_b64_tr_b16 v[110:111], v13 offset:7424
    ds_read_b64_tr_b16 v[112:113], v14
    ds_read_b64_tr_b16 v[114:115], v14 offset:512
    s_waitcnt lgkmcnt(0)
    s_lshl_b32 s28, s52, 10
    s_add_u32 s28, s28, 67108864
    buffer_store_dwordx4 v[112:115], v1, s[20:23], s28 offen sc1
    s_add_u32 s52, s52, 1
    v_mfma_f32_32x32x16_bf16 v[128:143], v[96:99], v[64:67], v[128:143]
    v_mfma_f32_32x32x16_bf16 v[128:143], v[100:103], v[68:71], v[128:143]
    v_mfma_f32_32x32x16_bf16 v[128:143], v[104:107], v[72:75], v[128:143]
    v_mfma_f32_32x32x16_bf16 v[128:143], v[108:111], v[76:79], v[128:143]
    s_cmp_lg_u32 s3, 4
    s_cbranch_scc1 sw_n2_35
    v_mfma_f32_32x32x16_bf16 v[144:159], v[96:99], v[80:83], v[144:159]
    v_mfma_f32_32x32x16_bf16 v[144:159], v[100:103], v[84:87], v[144:159]
    v_mfma_f32_32x32x16_bf16 v[144:159], v[104:107], v[88:91], v[144:159]
    v_mfma_f32_32x32x16_bf16 v[144:159], v[108:111], v[92:95], v[144:159]
sw_n2_35:
    buffer_load_dwordx4 v[64:67], v12, s[76:79], s48 offen offset:512
    buffer_load_dwordx4 v[68:71], v12, s[76:79], s48 offen offset:544
    buffer_load_dwordx4 v[72:75], v12, s[76:79], s48 offen offset:576
    buffer_load_dwordx4 v[76:79], v12, s[76:79], s48 offen offset:608
    s_cmp_lg_u32 s3, 4
    s_cbranch_scc1 sw_n3_36
    buffer_load_dwordx4 v[80:83], v12, s[76:79], s49 offen offset:512
    buffer_load_dwordx4 v[84:87], v12, s[76:79], s49 offen offset:544
    buffer_load_dwordx4 v[88:91], v12, s[76:79], s49 offen offset:576
    buffer_load_dwordx4 v[92:95], v12, s[76:79], s49 offen offset:608
sw_n3_36:
    s_cmp_lg_u32 s3, 6
    s_cbranch_scc1 sw_n4_37
    s_mov_b32 m0, 147456
    s_lshl_b32 s29, s67, 6
    s_add_u32 s28, s29, 262144
    buffer_load_dwordx4 v15, s[92:95], s28 offen offset:0 lds
    s_add_u32 s28, s29, 277504
    buffer_load_dwordx4 v15, s[92:95], s28 offen offset:1024 lds
    s_add_u32 s28, s29, 292864
    buffer_load_dwordx4 v15, s[92:95], s28 offen offset:2048 lds
    s_add_u32 s28, s29, 308224
    buffer_load_dwordx4 v15, s[92:95], s28 offen offset:3072 lds
sw_n4_37:
    s_lshr_b32 s28, s52, 4
    s_and_b32 s29, s52, 15
    s_lshl_b32 s29, s29, 6
    s_cmp_lt_u32 s28, 256
    s_cselect_b32 s16, s56, s60
    s_cselect_b32 s17, s57, s61
    s_cselect_b32 s18, 4194304, s94
    s_and_b32 s28, s28, 255
    s_lshl_b32 s28, s28, 14
    s_add_u32 s28, s28, s29
    s_mov_b32 m0, s51
    s_nop 0
    buffer_load_dwordx4 v15, s[16:19], s28 offen lds
    s_cmp_lg_u32 s3, 6
    s_cbranch_scc1 sw_n5_38
    s_waitcnt vmcnt(0)
sw_n5_38:
    s_barrier
    s_waitcnt vmcnt(0)
    ds_read_b64_tr_b16 v[96:97], v13 offset:0
    ds_read_b64_tr_b16 v[98:99], v13 offset:256
    ds_read_b64_tr_b16 v[100:101], v13 offset:1024
    ds_read_b64_tr_b16 v[102:103], v13 offset:1280
    ds_read_b64_tr_b16 v[104:105], v13 offset:2048
    ds_read_b64_tr_b16 v[106:107], v13 offset:2304
    ds_read_b64_tr_b16 v[108:109], v13 offset:3072
    ds_read_b64_tr_b16 v[110:111], v13 offset:3328
    ds_read_b64_tr_b16 v[112:113], v14
    ds_read_b64_tr_b16 v[114:115], v14 offset:512
    s_waitcnt lgkmcnt(0)
    s_lshl_b32 s28, s52, 10
    s_add_u32 s28, s28, 67108864
    buffer_store_dwordx4 v[112:115], v1, s[20:23], s28 offen sc1
    s_add_u32 s52, s52, 1
    v_mfma_f32_32x32x16_bf16 v[128:143], v[96:99], v[64:67], v[128:143]
    v_mfma_f32_32x32x16_bf16 v[128:143], v[100:103], v[68:71], v[128:143]
    v_mfma_f32_32x32x16_bf16 v[128:143], v[104:107], v[72:75], v[128:143]
    v_mfma_f32_32x32x16_bf16 v[128:143], v[108:111], v[76:79], v[128:143]
    s_cmp_lg_u32 s3, 4
    s_cbranch_scc1 sw_n2_39
    v_mfma_f32_32x32x16_bf16 v[144:159], v[96:99], v[80:83], v[144:159]
    v_mfma_f32_32x32x16_bf16 v[144:159], v[100:103], v[84:87], v[144:159]
    v_mfma_f32_32x32x16_bf16 v[144:159], v[104:107], v[88:91], v[144:159]
    v_mfma_f32_32x32x16_bf16 v[144:159], v[108:111], v[92:95], v[144:159]
sw_n2_39:
    buffer_load_dwordx4 v[64:67], v12, s[76:79], s48 offen offset:640
    buffer_load_dwordx4 v[68:71], v12, s[76:79], s48 offen offset:672
    buffer_load_dwordx4 v[72:75], v12, s[76:79], s48 offen offset:704
    buffer_load_dwordx4 v[76:79], v12, s[76:79], s48 offen offset:736
    s_cmp_lg_u32 s3, 4
    s_cbranch_scc1 sw_n3_40
    buffer_load_dwordx4 v[80:83], v12, s[76:79], s49 offen offset:640
    buffer_load_dwordx4 v[84:87], v12, s[76:79], s49 offen offset:672
    buffer_load_dwordx4 v[88:91], v12, s[76:79], s49 offen offset:704
    buffer_load_dwordx4 v[92:95], v12, s[76:79], s49 offen offset:736
sw_n3_40:
    s_cmp_lg_u32 s3, 6
    s_cbranch_scc1 sw_n4_41
    s_mov_b32 m0, 151552
    s_lshl_b32 s29, s67, 6
    s_add_u32 s28, s29, 327680
    buffer_load_dwordx4 v15, s[92:95], s28 offen offset:0 lds
    s_add_u32 s28, s29, 343040
    buffer_load_dwordx4 v15, s[92:95], s28 offen offset:1024 lds
    s_add_u32 s28, s29, 358400
    buffer_load_dwordx4 v15, s[92:95], s28 offen offset:2048 lds
    s_add_u32 s28, s29, 373760
    buffer_load_dwordx4 v15, s[92:95], s28 offen offset:3072 lds
sw_n4_41:
    s_lshr_b32 s28, s52, 4
    s_and_b32 s29, s52, 15
    s_lshl_b32 s29, s29, 6
    s_cmp_lt_u32 s28, 256
    s_cselect_b32 s16, s56, s60
    s_cselect_b32 s17, s57, s61
    s_cselect_b32 s18, 4194304, s94
    s_and_b32 s28, s28, 255
    s_lshl_b32 s28, s28, 14
    s_add_u32 s28, s28, s29
    s_mov_b32 m0, s51
    s_nop 0
    buffer_load_dwordx4 v15, s[16:19], s28 offen lds
    s_cmp_lg_u32 s3, 6
    s_cbranch_scc1 sw_n5_42
    s_waitcnt vmcnt(0)
sw_n5_42:
    s_barrier
    s_waitcnt vmcnt(0)
    ds_read_b64_tr_b16 v[96:97], v13 offset:4096
    ds_read_b64_tr_b16 v[98:99], v13 offset:4352
    ds_read_b64_tr_b16 v[100:101], v13 offset:5120
    ds_read_b64_tr_b16 v[102:103], v13 offset:5376
    ds_read_b64_tr_b16 v[104:105], v13 offset:6144
    ds_read_b64_tr_b16 v[106:107], v13 offset:6400
    ds_read_b64_tr_b16 v[108:109], v13 offset:7168
    ds_read_b64_tr_b16 v[110:111], v13 offset:7424
    ds_read_b64_tr_b16 v[112:113], v14
    ds_read_b64_tr_b16 v[114:115], v14 offset:512
    s_waitcnt lgkmcnt(0)
    s_lshl_b32 s28, s52, 10
    s_add_u32 s28, s28, 67108864
    buffer_store_dwordx4 v[112:115], v1, s[20:23], s28 offen sc1
    s_add_u32 s52, s52, 1
    v_mfma_f32_32x32x16_bf16 v[128:143], v[96:99], v[64:67], v[128:143]
    v_mfma_f32_32x32x16_bf16 v[128:143], v[100:103], v[68:71], v[128:143]
    v_mfma_f32_32x32x16_bf16 v[128:143], v[104:107], v[72:75], v[128:143]
    v_mfma_f32_32x32x16_bf16 v[128:143], v[108:111], v[76:79], v[128:143]
    s_cmp_lg_u32 s3, 4
    s_cbranch_scc1 sw_n2_43
    v_mfma_f32_32x32x16_bf16 v[144:159], v[96:99], v[80:83], v[144:159]
    v_mfma_f32_32x32x16_bf16 v[144:159], v[100:103], v[84:87], v[144:159]
    v_mfma_f32_32x32x16_bf16 v[144:159], v[104:107], v[88:91], v[144:159]
    v_mfma_f32_32x32x16_bf16 v[144:159], v[108:111], v[92:95], v[144:159]
sw_n2_43:
    buffer_load_dwordx4 v[64:67], v12, s[76:79], s48 offen offset:768
    buffer_load_dwordx4 v[68:71], v12, s[76:79], s48 offen offset:800
    buffer_load_dwordx4 v[72:75], v12, s[76:79], s48 offen offset:832
    buffer_load_dwordx4 v[76:79], v12, s[76:79], s48 offen offset:864
    s_cmp_lg_u32 s3, 4
    s_cbranch_scc1 sw_n3_44
    buffer_load_dwordx4 v[80:83], v12, s[76:79], s49 offen offset:768
    buffer_load_dwordx4 v[84:87], v12, s[76:79], s49 offen offset:800
    buffer_load_dwordx4 v[88:91], v12, s[76:79], s49 offen offset:832
    buffer_load_dwordx4 v[92:95], v12, s[76:79], s49 offen offset:864
sw_n3_44:
    s_cmp_lg_u32 s3, 6
    s_cbranch_scc1 sw_n4_45
    s_mov_b32 m0, 147456
    s_lshl_b32 s29, s67, 6
    s_add_u32 s28, s29, 393216
    buffer_load_dwordx4 v15, s[92:95], s28 offen offset:0 lds
    s_add_u32 s28, s29, 408576
    buffer_load_dwordx4 v15, s[92:95], s28 offen offset:1024 lds
    s_add_u32 s28, s29, 423936
    buffer_load_dwordx4 v15, s[92:95], s28 offen offset:2048 lds
    s_add_u32 s28, s29, 439296
    buffer_load_dwordx4 v15, s[92:95], s28 offen offset:3072 lds
sw_n4_45:
    s_cmp_lg_u32 s3, 6
    s_cbranch_scc1 sw_n5_46
    s_waitcnt vmcnt(0)
sw_n5_46:
    s_barrier
    s_waitcnt vmcnt(0)
    ds_read_b64_tr_b16 v[96:97], v13 offset:0
    ds_read_b64_tr_b16 v[98:99], v13 offset:256
    ds_read_b64_tr_b16 v[100:101], v13 offset:1024
    ds_read_b64_tr_b16 v[102:103], v13 offset:1280
    ds_read_b64_tr_b16 v[104:105], v13 offset:2048
    ds_read_b64_tr_b16 v[106:107], v13 offset:2304
    ds_read_b64_tr_b16 v[108:109], v13 offset:3072
    ds_read_b64_tr_b16 v[110:111], v13 offset:3328
    s_waitcnt lgkmcnt(0)
    v_mfma_f32_32x32x16_bf16 v[128:143], v[96:99], v[64:67], v[128:143]
    v_mfma_f32_32x32x16_bf16 v[128:143], v[100:103], v[68:71], v[128:143]
    v_mfma_f32_32x32x16_bf16 v[128:143], v[104:107], v[72:75], v[128:143]
    v_mfma_f32_32x32x16_bf16 v[128:143], v[108:111], v[76:79], v[128:143]
    s_cmp_lg_u32 s3, 4
    s_cbranch_scc1 sw_n2_47
    v_mfma_f32_32x32x16_bf16 v[144:159], v[96:99], v[80:83], v[144:159]
    v_mfma_f32_32x32x16_bf16 v[144:159], v[100:103], v[84:87], v[144:159]
    v_mfma_f32_32x32x16_bf16 v[144:159], v[104:107], v[88:91], v[144:159]
    v_mfma_f32_32x32x16_bf16 v[144:159], v[108:111], v[92:95], v[144:159]
sw_n2_47:
    buffer_load_dwordx4 v[64:67], v12, s[76:79], s48 offen offset:896
    buffer_load_dwordx4 v[68:71], v12, s[76:79], s48 offen offset:928
    buffer_load_dwordx4 v[72:75], v12, s[76:79], s48 offen offset:960
    buffer_load_dwordx4 v[76:79], v12, s[76:79], s48 offen offset:992
    s_cmp_lg_u32 s3, 4
    s_cbranch_scc1 sw_n3_48
    buffer_load_dwordx4 v[80:83], v12, s[76:79], s49 offen offset:896
    buffer_load_dwordx4 v[84:87], v12, s[76:79], s49 offen offset:928
    buffer_load_dwordx4 v[88:91], v12, s[76:79], s49 offen offset:960
    buffer_load_dwordx4 v[92:95], v12, s[76:79], s49 offen offset:992
sw_n3_48:
    s_cmp_lg_u32 s3, 6
    s_cbranch_scc1 sw_n4_49
    s_mov_b32 m0, 151552
    s_lshl_b32 s29, s67, 6
    s_add_u32 s28, s29, 458752
    buffer_load_dwordx4 v15, s[92:95], s28 offen offset:0 lds
    s_add_u32 s28, s29, 474112
    buffer_load_dwordx4 v15, s[92:95], s28 offen offset:1024 lds
    s_add_u32 s28, s29, 489472
    buffer_load_dwordx4 v15, s[92:95], s28 offen offset:2048 lds
    s_add_u32 s28, s29, 504832
    buffer_load_dwordx4 v15, s[92:95], s28 offen offset:3072 lds
sw_n4_49:
    s_cmp_lg_u32 s3, 6
    s_cbranch_scc1 sw_n5_50
    s_waitcnt vmcnt(0)
sw_n5_50:
    s_barrier
    s_waitcnt vmcnt(0)
    ds_read_b64_tr_b16 v[96:97], v13 offset:4096
    ds_read_b64_tr_b16 v[98:99], v13 offset:4352
    ds_read_b64_tr_b16 v[100:101], v13 offset:5120
    ds_read_b64_tr_b16 v[102:103], v13 offset:5376
    ds_read_b64_tr_b16 v[104:105], v13 offset:6144
    ds_read_b64_tr_b16 v[106:107], v13 offset:6400
    ds_read_b64_tr_b16 v[108:109], v13 offset:7168
    ds_read_b64_tr_b16 v[110:111], v13 offset:7424
    s_waitcnt lgkmcnt(0)
    v_mfma_f32_32x32x16_bf16 v[128:143], v[96:99], v[64:67], v[128:143]
    v_mfma_f32_32x32x16_bf16 v[128:143], v[100:103], v[68:71], v[128:143]
    v_mfma_f32_32x32x16_bf16 v[128:143], v[104:107], v[72:75], v[128:143]
    v_mfma_f32_32x32x16_bf16 v[128:143], v[108:111], v[76:79], v[128:143]
    s_cmp_lg_u32 s3, 4
    s_cbranch_scc1 sw_n2_51
    v_mfma_f32_32x32x16_bf16 v[144:159], v[96:99], v[80:83], v[144:159]
    v_mfma_f32_32x32x16_bf16 v[144:159], v[100:103], v[84:87], v[144:159]
    v_mfma_f32_32x32x16_bf16 v[144:159], v[104:107], v[88:91], v[144:159]
    v_mfma_f32_32x32x16_bf16 v[144:159], v[108:111], v[92:95], v[144:159]
sw_n2_51:
    s_cmp_lg_u32 s3, 5
    s_cbranch_scc1 sw_wf_52
    s_mov_b32 s40, 57680128
    v_mov_b32 v2, 1
    v_mov_b32 v3, 0
    s_mov_b64 exec, 1
    buffer_atomic_add v2, v3, s[20:23], s40 offen sc1
    s_mov_b64 exec, -1
sw_wf_52:
    s_barrier
    s_waitcnt vmcnt(0)
    s_waitcnt lgkmcnt(0)
    s_mov_b32 s28, 0x3eb8aa3b
    v_mul_f32 v128, s28, v128
    v_mul_f32 v129, s28, v129
    v_mul_f32 v130, s28, v130
    v_mul_f32 v131, s28, v131
    v_mul_f32 v132, s28, v132
    v_mul_f32 v133, s28, v133
    v_mul_f32 v134, s28, v134
    v_mul_f32 v135, s28, v135
    v_mul_f32 v136, s28, v136
    v_mul_f32 v137, s28, v137
    v_mul_f32 v138, s28, v138
    v_mul_f32 v139, s28, v139
    v_mul_f32 v140, s28, v140
    v_mul_f32 v141, s28, v141
    v_mul_f32 v142, s28, v142
    v_mul_f32 v143, s28, v143
    v_mul_f32 v144, s28, v144
    v_mul_f32 v145, s28, v145
    v_mul_f32 v146, s28, v146
    v_mul_f32 v147, s28, v147
    v_mul_f32 v148, s28, v148
    v_mul_f32 v149, s28, v149
    v_mul_f32 v150, s28, v150
    v_mul_f32 v151, s28, v151
    v_mul_f32 v152, s28, v152
    v_mul_f32 v153, s28, v153
    v_mul_f32 v154, s28, v154
    v_mul_f32 v155, s28, v155
    v_mul_f32 v156, s28, v156
    v_mul_f32 v157, s28, v157
    v_mul_f32 v158, s28, v158
    v_mul_f32 v159, s28, v159
    v_cvt_pk_bf16_f32 v64, v128, v129
    v_cvt_pk_bf16_f32 v65, v130, v131
    v_cvt_pk_bf16_f32 v66, v132, v133
    v_cvt_pk_bf16_f32 v67, v134, v135
    v_cvt_pk_bf16_f32 v68, v136, v137
    v_cvt_pk_bf16_f32 v69, v138, v139
    v_cvt_pk_bf16_f32 v70, v140, v141
    v_cvt_pk_bf16_f32 v71, v142, v143
    v_cvt_pk_bf16_f32 v72, v144, v145
    v_cvt_pk_bf16_f32 v73, v146, v147
    v_cvt_pk_bf16_f32 v74, v148, v149
    v_cvt_pk_bf16_f32 v75, v150, v151
    v_cvt_pk_bf16_f32 v76, v152, v153
    v_cvt_pk_bf16_f32 v77, v154, v155
    v_cvt_pk_bf16_f32 v78, v156, v157
    v_cvt_pk_bf16_f32 v79, v158, v159
    s_lshl_b32 s28, s2, 13
    s_lshl_b32 s29, s45, 11
    s_add_u32 s29, s29, s28
    s_add_u32 s29, s29, 73400320
    buffer_store_dwordx4 v[64:67], v1, s[20:23], s29 offen sc1
    buffer_store_dwordx4 v[68:71], v1, s[20:23], s29 offen offset:1024 sc1
    s_cmp_lg_u32 s3, 4
    s_cbranch_scc1 sw_q3
    s_add_u32 s29, s28, 73406464
    buffer_store_dwordx4 v[72:75], v1, s[20:23], s29 offen sc1
    buffer_store_dwordx4 v[76:79], v1, s[20:23], s29 offen offset:1024 sc1
sw_q3:
    s_waitcnt vmcnt(0)
    s_mov_b32 s58, 40
    s_cmp_ge_u32 s2, 64
    s_cbranch_scc1 sw_chk
    s_barrier
    s_cmp_eq_u32 s3, 4
    s_cbranch_scc1 sw_x_53
    v_and_b32 v30, 31, v0
    v_lshrrev_b32 v31, 5, v0
    v_lshlrev_b32 v30, 10, v30
    v_lshlrev_b32 v31, 4, v31
    v_add_u32 v30, v31, v30
    v_lshrrev_b32 v5, 4, v0
    v_and_b32 v4, 15, v0
    v_and_b32 v6, 1, v5
    v_lshlrev_b32 v6, 11, v6
    v_lshrrev_b32 v2, 1, v5
    v_lshlrev_b32 v2, 3, v2
    v_lshrrev_b32 v3, 2, v4
    v_add_u32 v2, v2, v3
    v_lshl_add_u32 v6, v2, 5, v6
    v_and_b32 v3, 3, v4
    v_lshl_add_u32 v6, v3, 3, v6
    s_sub_u32 s40, s3, 5
    s_lshl_b32 s28, s40, 12
    s_add_u32 s28, s28, 147456
    v_add_u32 v6, s28, v6
    v_mov_b32 v7, 0
    s_sub_u32 s40, s3, 5
    s_lshl_b32 s28, s2, 15
    s_lshl_b32 s29, s40, 7
    s_add_u32 s29, s29, 0
    s_add_u32 s28, s28, s29
    buffer_load_dwordx4 v[112:115], v30, s[76:79], s28 offen offset:0
    buffer_load_dwordx4 v[116:119], v30, s[76:79], s28 offen offset:32
    buffer_load_dwordx4 v[120:123], v30, s[76:79], s28 offen offset:64
    buffer_load_dwordx4 v[124:127], v30, s[76:79], s28 offen offset:96
    buffer_load_dwordx4 v[160:163], v31, s[88:91], s29 offen offset:0
    buffer_load_dwordx4 v[164:167], v31, s[88:91], s29 offen offset:32
    buffer_load_dwordx4 v[168:171], v31, s[88:91], s29 offen offset:64
    buffer_load_dwordx4 v[172:175], v31, s[88:91], s29 offen offset:96
    s_lshl_b32 s28, s40, 12
    s_add_u32 m0, s28, 147456
    s_lshl_b32 s29, s40, 11
    s_add_u32 s29, s29, 0
    s_mov_b32 s92, s70
    s_mov_b32 s93, s71
    s_mov_b32 s94, 16384
    s_mov_b32 s95, 0x00020000
    buffer_load_dwordx4 v1, s[92:95], s29 offen lds
    buffer_load_dwordx4 v1, s[92:95], s29 offen offset:1024 lds
    s_add_u32 m0, s28, 149504
    s_mov_b32 s92, s68
    s_mov_b32 s93, s69
    buffer_load_dwordx4 v1, s[92:95], s29 offen lds
    buffer_load_dwordx4 v1, s[92:95], s29 offen offset:1024 lds
k1_x10:
sw_x_53:
    s_barrier
    s_cmp_eq_u32 s3, 4
    s_cbranch_scc1 sw_x_54
    s_sub_u32 s40, s3, 5
    s_lshl_b32 s29, s2, 15
    s_lshl_b32 s28, s40, 12
    s_add_u32 s29, s29, s28
    s_add_u32 s29, s29, 58720256
    s_waitcnt vmcnt(0)
    ds_read_b64_tr_b16 v[176:177], v6 offset:0
    ds_read_b64_tr_b16 v[178:179], v6 offset:128
    ds_read_b64_tr_b16 v[180:181], v6 offset:512
    ds_read_b64_tr_b16 v[182:183], v6 offset:640
    ds_read_b64_tr_b16 v[184:185], v6 offset:1024
    ds_read_b64_tr_b16 v[186:187], v6 offset:1152
    ds_read_b64_tr_b16 v[188:189], v6 offset:1536
    ds_read_b64_tr_b16 v[190:191], v6 offset:1664
    s_waitcnt lgkmcnt(0)
    v_mfma_f32_32x32x16_bf16 v[128:143], v[176:179], v[112:115], 0
    v_mfma_f32_32x32x16_bf16 v[144:159], v[112:115], v[176:179], 0
    v_dot2_f32_bf16 v7, v112, v160, v7
    v_dot2_f32_bf16 v7, v113, v161, v7
    v_dot2_f32_bf16 v7, v114, v162, v7
    v_dot2_f32_bf16 v7, v115, v163, v7
    v_mfma_f32_32x32x16_bf16 v[128:143], v[180:183], v[116:119], v[128:143]
    v_mfma_f32_32x32x16_bf16 v[144:159], v[116:119], v[180:183], v[144:159]
    v_dot2_f32_bf16 v7, v116, v164, v7
    v_dot2_f32_bf16 v7, v117, v165, v7
    v_dot2_f32_bf16 v7, v118, v166, v7
    v_dot2_f32_bf16 v7, v119, v167, v7
    v_mfma_f32_32x32x16_bf16 v[128:143], v[184:187], v[120:123], v[128:143]
    v_mfma_f32_32x32x16_bf16 v[144:159], v[120:123], v[184:187], v[144:159]
    v_dot2_f32_bf16 v7, v120, v168, v7
    v_dot2_f32_bf16 v7, v121, v169, v7
    v_dot2_f32_bf16 v7, v122, v170, v7
    v_dot2_f32_bf16 v7, v123, v171, v7
    v_mfma_f32_32x32x16_bf16 v[128:143], v[188:191], v[124:127], v[128:143]
    v_mfma_f32_32x32x16_bf16 v[144:159], v[124:127], v[188:191], v[144:159]
    v_dot2_f32_bf16 v7, v124, v172, v7
    v_dot2_f32_bf16 v7, v125, v173, v7
    v_dot2_f32_bf16 v7, v126, v174, v7
    v_dot2_f32_bf16 v7, v127, v175, v7
    s_nop 3
    s_sub_u32 s40, s3, 5
    s_lshl_b32 s28, s2, 15
    s_lshl_b32 s29, s40, 7
    s_add_u32 s29, s29, 256
    s_add_u32 s28, s28, s29
    buffer_load_dwordx4 v[112:115], v30, s[76:79], s28 offen offset:0
    buffer_load_dwordx4 v[116:119], v30, s[76:79], s28 offen offset:32
    buffer_load_dwordx4 v[120:123], v30, s[76:79], s28 offen offset:64
    buffer_load_dwordx4 v[124:127], v30, s[76:79], s28 offen offset:96
    buffer_load_dwordx4 v[160:163], v31, s[88:91], s29 offen offset:0
    buffer_load_dwordx4 v[164:167], v31, s[88:91], s29 offen offset:32
    buffer_load_dwordx4 v[168:171], v31, s[88:91], s29 offen offset:64
    buffer_load_dwordx4 v[172:175], v31, s[88:91], s29 offen offset:96
    s_lshl_b32 s28, s40, 12
    s_add_u32 m0, s28, 147456
    s_lshl_b32 s29, s40, 11
    s_add_u32 s29, s29, 4096
    s_mov_b32 s92, s70
    s_mov_b32 s93, s71
    s_mov_b32 s94, 16384
    s_mov_b32 s95, 0x00020000
    buffer_load_dwordx4 v1, s[92:95], s29 offen lds
    buffer_load_dwordx4 v1, s[92:95], s29 offen offset:1024 lds
    s_add_u32 m0, s28, 149504
    s_mov_b32 s92, s68
    s_mov_b32 s93, s69
    buffer_load_dwordx4 v1, s[92:95], s29 offen lds
    buffer_load_dwordx4 v1, s[92:95], s29 offen offset:1024 lds
k1_x11:
sw_x_54:
    s_barrier
    s_cmp_eq_u32 s3, 4
    s_cbranch_scc1 sw_x_55
    s_sub_u32 s40, s3, 5
    s_lshl_b32 s29, s2, 15
    s_lshl_b32 s28, s40, 12
    s_add_u32 s29, s29, s28
    s_add_u32 s29, s29, 58728448
    s_waitcnt vmcnt(0)
    ds_read_b64_tr_b16 v[176:177], v6 offset:0
    ds_read_b64_tr_b16 v[178:179], v6 offset:128
    ds_read_b64_tr_b16 v[180:181], v6 offset:512
    ds_read_b64_tr_b16 v[182:183], v6 offset:640
    ds_read_b64_tr_b16 v[184:185], v6 offset:1024
    ds_read_b64_tr_b16 v[186:187], v6 offset:1152
    ds_read_b64_tr_b16 v[188:189], v6 offset:1536
    ds_read_b64_tr_b16 v[190:191], v6 offset:1664
    s_waitcnt lgkmcnt(0)
    v_mfma_f32_32x32x16_bf16 v[128:143], v[176:179], v[112:115], v[128:143]
    v_mfma_f32_32x32x16_bf16 v[144:159], v[112:115], v[176:179], v[144:159]
    v_dot2_f32_bf16 v7, v112, v160, v7
    v_dot2_f32_bf16 v7, v113, v161, v7
    v_dot2_f32_bf16 v7, v114, v162, v7
    v_dot2_f32_bf16 v7, v115, v163, v7
    v_mfma_f32_32x32x16_bf16 v[128:143], v[180:183], v[116:119], v[128:143]
    v_mfma_f32_32x32x16_bf16 v[144:159], v[116:119], v[180:183], v[144:159]
    v_dot2_f32_bf16 v7, v116, v164, v7
    v_dot2_f32_bf16 v7, v117, v165, v7
    v_dot2_f32_bf16 v7, v118, v166, v7
    v_dot2_f32_bf16 v7, v119, v167, v7
    v_mfma_f32_32x32x16_bf16 v[128:143], v[184:187], v[120:123], v[128:143]
    v_mfma_f32_32x32x16_bf16 v[144:159], v[120:123], v[184:187], v[144:159]
    v_dot2_f32_bf16 v7, v120, v168, v7
    v_dot2_f32_bf16 v7, v121, v169, v7
    v_dot2_f32_bf16 v7, v122, v170, v7
    v_dot2_f32_bf16 v7, v123, v171, v7
    v_mfma_f32_32x32x16_bf16 v[128:143], v[188:191], v[124:127], v[128:143]
    v_mfma_f32_32x32x16_bf16 v[144:159], v[124:127], v[188:191], v[144:159]
    v_dot2_f32_bf16 v7, v124, v172, v7
    v_dot2_f32_bf16 v7, v125, v173, v7
    v_dot2_f32_bf16 v7, v126, v174, v7
    v_dot2_f32_bf16 v7, v127, v175, v7
    s_nop 3
    s_sub_u32 s40, s3, 5
    s_lshl_b32 s28, s2, 15
    s_lshl_b32 s29, s40, 7
    s_add_u32 s29, s29, 512
    s_add_u32 s28, s28, s29
    buffer_load_dwordx4 v[112:115], v30, s[76:79], s28 offen offset:0
    buffer_load_dwordx4 v[116:119], v30, s[76:79], s28 offen offset:32
    buffer_load_dwordx4 v[120:123], v30, s[76:79], s28 offen offset:64
    buffer_load_dwordx4 v[124:127], v30, s[76:79], s28 offen offset:96
    buffer_load_dwordx4 v[160:163], v31, s[88:91], s29 offen offset:0
    buffer_load_dwordx4 v[164:167], v31, s[88:91], s29 offen offset:32
    buffer_load_dwordx4 v[168:171], v31, s[88:91], s29 offen offset:64
    buffer_load_dwordx4 v[172:175], v31, s[88:91], s29 offen offset:96
    s_lshl_b32 s28, s40, 12
    s_add_u32 m0, s28, 147456
    s_lshl_b32 s29, s40, 11
    s_add_u32 s29, s29, 8192
    s_mov_b32 s92, s70
    s_mov_b32 s93, s71
    s_mov_b32 s94, 16384
    s_mov_b32 s95, 0x00020000
    buffer_load_dwordx4 v1, s[92:95], s29 offen lds
    buffer_load_dwordx4 v1, s[92:95], s29 offen offset:1024 lds
    s_add_u32 m0, s28, 149504
    s_mov_b32 s92, s68
    s_mov_b32 s93, s69
    buffer_load_dwordx4 v1, s[92:95], s29 offen lds
    buffer_load_dwordx4 v1, s[92:95], s29 offen offset:1024 lds
k1_x12:
sw_x_55:
    s_barrier
    s_cmp_eq_u32 s3, 4
    s_cbranch_scc1 sw_x_56
    s_sub_u32 s40, s3, 5
    s_lshl_b32 s29, s2, 15
    s_lshl_b32 s28, s40, 12
    s_add_u32 s29, s29, s28
    s_add_u32 s29, s29, 58736640
    s_waitcnt vmcnt(0)
    ds_read_b64_tr_b16 v[176:177], v6 offset:0
    ds_read_b64_tr_b16 v[178:179], v6 offset:128
    ds_read_b64_tr_b16 v[180:181], v6 offset:512
    ds_read_b64_tr_b16 v[182:183], v6 offset:640
    ds_read_b64_tr_b16 v[184:185], v6 offset:1024
    ds_read_b64_tr_b16 v[186:187], v6 offset:1152
    ds_read_b64_tr_b16 v[188:189], v6 offset:1536
    ds_read_b64_tr_b16 v[190:191], v6 offset:1664
    s_waitcnt lgkmcnt(0)
    v_mfma_f32_32x32x16_bf16 v[128:143], v[176:179], v[112:115], v[128:143]
    v_mfma_f32_32x32x16_bf16 v[144:159], v[112:115], v[176:179], v[144:159]
    v_dot2_f32_bf16 v7, v112, v160, v7
    v_dot2_f32_bf16 v7, v113, v161, v7
    v_dot2_f32_bf16 v7, v114, v162, v7
    v_dot2_f32_bf16 v7, v115, v163, v7
    v_mfma_f32_32x32x16_bf16 v[128:143], v[180:183], v[116:119], v[128:143]
    v_mfma_f32_32x32x16_bf16 v[144:159], v[116:119], v[180:183], v[144:159]
    v_dot2_f32_bf16 v7, v116, v164, v7
    v_dot2_f32_bf16 v7, v117, v165, v7
    v_dot2_f32_bf16 v7, v118, v166, v7
    v_dot2_f32_bf16 v7, v119, v167, v7
    v_mfma_f32_32x32x16_bf16 v[128:143], v[184:187], v[120:123], v[128:143]
    v_mfma_f32_32x32x16_bf16 v[144:159], v[120:123], v[184:187], v[144:159]
    v_dot2_f32_bf16 v7, v120, v168, v7
    v_dot2_f32_bf16 v7, v121, v169, v7
    v_dot2_f32_bf16 v7, v122, v170, v7
    v_dot2_f32_bf16 v7, v123, v171, v7
    v_mfma_f32_32x32x16_bf16 v[128:143], v[188:191], v[124:127], v[128:143]
    v_mfma_f32_32x32x16_bf16 v[144:159], v[124:127], v[188:191], v[144:159]
    v_dot2_f32_bf16 v7, v124, v172, v7
    v_dot2_f32_bf16 v7, v125, v173, v7
    v_dot2_f32_bf16 v7, v126, v174, v7
    v_dot2_f32_bf16 v7, v127, v175, v7
    s_nop 3
    s_sub_u32 s40, s3, 5
    s_lshl_b32 s28, s2, 15
    s_lshl_b32 s29, s40, 7
    s_add_u32 s29, s29, 768
    s_add_u32 s28, s28, s29
    buffer_load_dwordx4 v[112:115], v30, s[76:79], s28 offen offset:0
    buffer_load_dwordx4 v[116:119], v30, s[76:79], s28 offen offset:32
    buffer_load_dwordx4 v[120:123], v30, s[76:79], s28 offen offset:64
    buffer_load_dwordx4 v[124:127], v30, s[76:79], s28 offen offset:96
    buffer_load_dwordx4 v[160:163], v31, s[88:91], s29 offen offset:0
    buffer_load_dwordx4 v[164:167], v31, s[88:91], s29 offen offset:32
    buffer_load_dwordx4 v[168:171], v31, s[88:91], s29 offen offset:64
    buffer_load_dwordx4 v[172:175], v31, s[88:91], s29 offen offset:96
    s_lshl_b32 s28, s40, 12
    s_add_u32 m0, s28, 147456
    s_lshl_b32 s29, s40, 11
    s_add_u32 s29, s29, 12288
    s_mov_b32 s92, s70
    s_mov_b32 s93, s71
    s_mov_b32 s94, 16384
    s_mov_b32 s95, 0x00020000
    buffer_load_dwordx4 v1, s[92:95], s29 offen lds
    buffer_load_dwordx4 v1, s[92:95], s29 offen offset:1024 lds
    s_add_u32 m0, s28, 149504
    s_mov_b32 s92, s68
    s_mov_b32 s93, s69
    buffer_load_dwordx4 v1, s[92:95], s29 offen lds
    buffer_load_dwordx4 v1, s[92:95], s29 offen offset:1024 lds
k1_x13:
sw_x_56:
    s_barrier
    s_cmp_eq_u32 s3, 4
    s_cbranch_scc1 sw_x_57
    s_sub_u32 s40, s3, 5
    s_lshl_b32 s29, s2, 15
    s_lshl_b32 s28, s40, 12
    s_add_u32 s29, s29, s28
    s_add_u32 s29, s29, 58744832
    s_waitcnt vmcnt(0)
    ds_read_b64_tr_b16 v[176:177], v6 offset:0
    ds_read_b64_tr_b16 v[178:179], v6 offset:128
    ds_read_b64_tr_b16 v[180:181], v6 offset:512
    ds_read_b64_tr_b16 v[182:183], v6 offset:640
    ds_read_b64_tr_b16 v[184:185], v6 offset:1024
    ds_read_b64_tr_b16 v[186:187], v6 offset:1152
    ds_read_b64_tr_b16 v[188:189], v6 offset:1536
    ds_read_b64_tr_b16 v[190:191], v6 offset:1664
    s_waitcnt lgkmcnt(0)
    v_mfma_f32_32x32x16_bf16 v[128:143], v[176:179], v[112:115], v[128:143]
    v_mfma_f32_32x32x16_bf16 v[144:159], v[112:115], v[176:179], v[144:159]
    v_dot2_f32_bf16 v7, v112, v160, v7
    v_dot2_f32_bf16 v7, v113, v161, v7
    v_dot2_f32_bf16 v7, v114, v162, v7
    v_dot2_f32_bf16 v7, v115, v163, v7
    v_mfma_f32_32x32x16_bf16 v[128:143], v[180:183], v[116:119], v[128:143]
    v_mfma_f32_32x32x16_bf16 v[144:159], v[116:119], v[180:183], v[144:159]
    v_dot2_f32_bf16 v7, v116, v164, v7
    v_dot2_f32_bf16 v7, v117, v165, v7
    v_dot2_f32_bf16 v7, v118, v166, v7
    v_dot2_f32_bf16 v7, v119, v167, v7
    v_mfma_f32_32x32x16_bf16 v[128:143], v[184:187], v[120:123], v[128:143]
    v_mfma_f32_32x32x16_bf16 v[144:159], v[120:123], v[184:187], v[144:159]
    v_dot2_f32_bf16 v7, v120, v168, v7
    v_dot2_f32_bf16 v7, v121, v169, v7
    v_dot2_f32_bf16 v7, v122, v170, v7
    v_dot2_f32_bf16 v7, v123, v171, v7
    v_mfma_f32_32x32x16_bf16 v[128:143], v[188:191], v[124:127], v[128:143]
    v_mfma_f32_32x32x16_bf16 v[144:159], v[124:127], v[188:191], v[144:159]
    v_dot2_f32_bf16 v7, v124, v172, v7
    v_dot2_f32_bf16 v7, v125, v173, v7
    v_dot2_f32_bf16 v7, v126, v174, v7
    v_dot2_f32_bf16 v7, v127, v175, v7
    s_cmp_lg_u32 s3, 6
    s_cbranch_scc1 k1_x14
    v_add_u32 v2, 155904, v1
    v_lshlrev_b32 v3, 2, v0
    v_add_u32 v3, 162048, v3
    s_nop 15
    ds_write_b128 v2, v[136:139] offset:0
    ds_write_b128 v2, v[140:143] offset:1024
    ds_write_b128 v2, v[144:147] offset:2048
    ds_write_b128 v2, v[148:151] offset:3072
    ds_write_b128 v2, v[152:155] offset:4096
    ds_write_b128 v2, v[156:159] offset:5120
    ds_write_b32 v3, v7
    s_waitcnt lgkmcnt(0)
k1_x14:
sw_x_57:
    s_barrier
    s_cmp_eq_u32 s3, 4
    s_cbranch_scc1 sw_x_58
    s_cmp_lg_u32 s3, 5
    s_cbranch_scc1 k1_x15
    v_add_u32 v2, 155904, v1
    v_lshlrev_b32 v3, 2, v0
    v_add_u32 v3, 162048, v3
    ds_read_b128 v[160:163], v2 offset:0
    ds_read_b128 v[164:167], v2 offset:1024
    ds_read_b128 v[168:171], v2 offset:2048
    ds_read_b128 v[172:175], v2 offset:3072
    ds_read_b128 v[176:179], v2 offset:4096
    ds_read_b128 v[180:183], v2 offset:5120
    ds_read_b32 v184, v3
    s_waitcnt lgkmcnt(0)
    v_add_f32 v136, v136, v160
    v_add_f32 v137, v137, v161
    v_add_f32 v138, v138, v162
    v_add_f32 v139, v139, v163
    v_add_f32 v140, v140, v164
    v_add_f32 v141, v141, v165
    v_add_f32 v142, v142, v166
    v_add_f32 v143, v143, v167
    v_add_f32 v144, v144, v168
    v_add_f32 v145, v145, v169
    v_add_f32 v146, v146, v170
    v_add_f32 v147, v147, v171
    v_add_f32 v148, v148, v172
    v_add_f32 v149, v149, v173
    v_add_f32 v150, v150, v174
    v_add_f32 v151, v151, v175
    v_add_f32 v152, v152, v176
    v_add_f32 v153, v153, v177
    v_add_f32 v154, v154, v178
    v_add_f32 v155, v155, v179
    v_add_f32 v156, v156, v180
    v_add_f32 v157, v157, v181
    v_add_f32 v158, v158, v182
    v_add_f32 v159, v159, v183
    v_add_f32 v7, v7, v184
    v_cvt_pk_bf16_f32 v160, v136, v137
    v_cvt_pk_bf16_f32 v161, v138, v139
    v_cvt_pk_bf16_f32 v162, v140, v141
    v_cvt_pk_bf16_f32 v163, v142, v143
    v_cvt_pk_bf16_f32 v164, v144, v145
    v_cvt_pk_bf16_f32 v165, v146, v147
    v_cvt_pk_bf16_f32 v166, v148, v149
    v_cvt_pk_bf16_f32 v167, v150, v151
    v_cvt_pk_bf16_f32 v168, v152, v153
    v_cvt_pk_bf16_f32 v169, v154, v155
    v_cvt_pk_bf16_f32 v170, v156, v157
    v_cvt_pk_bf16_f32 v171, v158, v159
    s_lshl_b32 s28, s2, 10
    s_add_u32 s29, s28, 33554432
    buffer_store_dwordx4 v[160:163], v1, s[20:23], s29 offen sc1
    v_and_b32 v2, 31, v0
    v_lshrrev_b32 v3, 5, v0
    v_lshl_add_u32 v3, v3, 4, v2
    v_lshlrev_b32 v3, 4, v3
    s_add_u32 s29, s28, 33619968
    v_cmp_gt_u32 vcc, 16, v2
    s_and_saveexec_b64 s[62:63], vcc
    buffer_store_dwordx4 v[164:167], v3, s[20:23], s29 offen sc1
    buffer_store_dwordx4 v[168:171], v3, s[20:23], s29 offen offset:512 sc1
    s_mov_b64 exec, s[62:63]
    v_mov_b32 v2, v7
    s_nop 1
    v_permlane32_swap_b32 v2, v7
    s_nop 1
    v_add_f32 v7, v7, v2
    v_cvt_pk_bf16_f32 v7, v7, v7
    v_lshlrev_b32 v7, 16, v7
    v_mul_f32 v7, 0xbfb8aa3b, v7
    v_exp_f32 v7, v7
    s_nop 0
    v_add_f32 v7, 1.0, v7
    v_rcp_f32 v7, v7
    s_nop 0
    v_cvt_pk_bf16_f32 v7, v7, v7
    v_lshlrev_b32 v172, 16, v7
    v_sub_f32 v173, 1.0, v172
    v_cvt_pk_bf16_f32 v173, v173, v173
    v_lshlrev_b32 v173, 16, v173
    v_lshlrev_b32 v3, 3, v0
    s_lshl_b32 s28, s2, 8
    s_add_u32 s28, s28, 33816576
    v_cmp_gt_u32 vcc, 32, v0
    s_and_saveexec_b64 s[62:63], vcc
    buffer_store_dwordx2 v[172:173], v3, s[20:23], s28 offen sc1
    s_mov_b64 exec, s[62:63]
    s_waitcnt vmcnt(0)
    s_mov_b32 s40, 57679872
    v_mov_b32 v2, 1
    v_mov_b32 v3, 0
    s_mov_b64 exec, 1
    buffer_atomic_add v2, v3, s[20:23], s40 offen sc1
    s_mov_b64 exec, -1
k1_x15:
sw_x_58:
    s_mov_b32 s58, 64
    s_branch sw_chk
sw_task:
    s_mov_b32 s58, 0
sw_loop:
    s_barrier
    s_add_u32 s58, s58, 4
sw_chk:
    s_add_u32 s28, s50, 2
    s_cmp_lt_u32 s58, s28
    s_cbranch_scc1 sw_loop
    s_barrier
    v_mov_b32 v32, 155648
    ds_read_b128 v[34:37], v32
    s_waitcnt lgkmcnt(0)
    v_or3_b32 v32, v34, v35, v36
    v_or_b32 v32, v32, v37
    s_nop 0
    v_readfirstlane_b32 s28, v32
    s_cmp_eq_u32 s28, 0
    s_cbranch_scc1 sw_ok
    s_cmp_lg_u32 s44, 0
    s_cbranch_scc1 sw_ok
    s_mov_b32 s44, 1
    s_mov_b32 s58, 0
sw_max:
    s_barrier
    s_barrier
    s_add_u32 s58, s58, 1
    s_cmp_lt_u32 s58, s50
    s_cbranch_scc1 sw_max
    s_branch sw_task
sw_ok:
    s_mov_b32 s44, 0
    s_add_u32 s46, s46, 1
    s_cmp_ge_u32 s46, 2
    s_cbranch_scc1 p3_a
    s_sub_u32 s47, 15, s7
    s_cmp_eq_u32 s46, 0
    s_cselect_b32 s47, s47, s7
    s_lshl_b32 s50, s47, 2
    s_add_u32 s50, s50, 4
    s_branch sw_task
l_task:
    s_mov_b32 s58, 0
    s_mov_b32 s57, 0
l_loop:
    s_waitcnt vmcnt(0)
    s_barrier
    s_mov_b32 s59, 0
    s_lshr_b32 s28, s52, 13
    s_add_u32 s28, s28, 4
    s_lshr_b32 s28, s28, 3
    s_min_u32 s28, s28, 7
    s_lshl_b32 s29, 2, s28
    s_sub_u32 s29, s29, 1
    s_and_b32 s28, s61, s29
    s_cmp_eq_u32 s28, s29
    s_cbranch_scc1 l_rbok_59
    s_lshl_b32 s40, s6, 8
    s_add_u32 s40, s40, 57688064
    v_mov_b32 v4, 0
    s_mov_b32 s41, 0
l_rbpoll_60:
    buffer_load_dwordx2 v[2:3], v4, s[20:23], s40 offen sc1
    s_waitcnt vmcnt(0)
    v_readfirstlane_b32 s61, v2
    v_readfirstlane_b32 s28, v3
    s_mul_i32 s61, s61, 0x01020408
    s_lshr_b32 s61, s61, 24
    s_and_b32 s61, s61, 15
    s_mul_i32 s28, s28, 0x01020408
    s_lshr_b32 s28, s28, 20
    s_and_b32 s28, s28, 0xf0
    s_or_b32 s61, s61, s28
    s_and_b32 s28, s61, s29
    s_cmp_eq_u32 s28, s29
    s_cbranch_scc1 l_rbgot_61
    s_sleep 4
    s_add_u32 s41, s41, 1
    s_cmp_lt_u32 s41, 0x100000
    s_cbranch_scc1 l_rbpoll_60
l_rbgot_61:
l_rbok_59:
l_in:
    s_cmp_lg_u32 s57, 0
    s_cbranch_scc1 l_do
    s_add_u32 s28, s50, 2
    s_lshl_b32 s28, s28, 13
    s_cmp_lt_u32 s52, s28
    s_cbranch_scc1 l_do
    s_add_u32 s28, s28, 16384
    s_cmp_lt_u32 s52, s28
    s_cbranch_scc1 l_skip
    s_cmp_lg_u32 s46, 0
    s_cbranch_scc1 l_skip
    s_mov_b32 s57, 1
    s_mov_b32 s52, 0
    s_branch l_do
l_skip:
    s_add_u32 s52, s52, 8192
    s_add_u32 s53, s53, 16384
    s_cmp_ge_u32 s53, 147456
    s_cselect_b32 s53, 0, s53
    s_branch l_nx
l_do:
    s_add_u32 m0, s53, 0
    s_add_u32 s28, s52, 0
    buffer_load_dwordx4 v1, s[84:87], s28 offen offset:0 sc1 lds
    buffer_load_dwordx4 v1, s[84:87], s28 offen offset:1024 sc1 lds
    buffer_load_dwordx4 v1, s[84:87], s28 offen offset:2048 sc1 lds
    buffer_load_dwordx4 v1, s[84:87], s28 offen offset:3072 sc1 lds
    s_add_u32 m0, s53, 4096
    s_add_u32 s28, s52, 4096
    buffer_load_dwordx4 v1, s[84:87], s28 offen offset:0 sc1 lds
    buffer_load_dwordx4 v1, s[84:87], s28 offen offset:1024 sc1 lds
    buffer_load_dwordx4 v1, s[84:87], s28 offen offset:2048 sc1 lds
    buffer_load_dwordx4 v1, s[84:87], s28 offen offset:3072 sc1 lds
    s_add_u32 m0, s53, 8192
    s_add_u32 s28, s52, 0
    buffer_load_dwordx4 v1, s[32:35], s28 offen offset:0 sc1 lds
    buffer_load_dwordx4 v1, s[32:35], s28 offen offset:1024 sc1 lds
    buffer_load_dwordx4 v1, s[32:35], s28 offen offset:2048 sc1 lds
    buffer_load_dwordx4 v1, s[32:35], s28 offen offset:3072 sc1 lds
    s_add_u32 m0, s53, 12288
    s_add_u32 s28, s52, 4096
    buffer_load_dwordx4 v1, s[32:35], s28 offen offset:0 sc1 lds
    buffer_load_dwordx4 v1, s[32:35], s28 offen offset:1024 sc1 lds
    buffer_load_dwordx4 v1, s[32:35], s28 offen offset:2048 sc1 lds
    buffer_load_dwordx4 v1, s[32:35], s28 offen offset:3072 sc1 lds
    s_add_u32 s52, s52, 8192
    s_add_u32 s53, s53, 16384
    s_cmp_ge_u32 s53, 147456
    s_cselect_b32 s53, 0, s53
l_nx:
    s_add_u32 s59, s59, 1
    s_cmp_lt_u32 s59, 4
    s_cbranch_scc1 l_in
    s_add_u32 s58, s58, 4
    s_add_u32 s28, s50, 2
    s_cmp_lt_u32 s58, s28
    s_cbranch_scc1 l_loop
    s_barrier
    v_mov_b32 v32, 155648
    ds_read_b128 v[34:37], v32
    s_waitcnt lgkmcnt(0)
    v_or3_b32 v32, v34, v35, v36
    v_or_b32 v32, v32, v37
    s_nop 0
    v_readfirstlane_b32 s28, v32
    s_cmp_eq_u32 s28, 0
    s_cbranch_scc1 l_ok
    s_cmp_lg_u32 s60, 0
    s_cbranch_scc1 l_ok
    s_mov_b32 s60, 1
    s_mov_b32 s58, 0
    s_waitcnt vmcnt(0)
l_max:
    s_lshl_b32 s52, s58, 13
    s_mov_b32 m0, 0
    s_add_u32 s28, s52, 0
    buffer_load_dwordx4 v1, s[84:87], s28 offen offset:0 sc1 lds
    buffer_load_dwordx4 v1, s[84:87], s28 offen offset:1024 sc1 lds
    buffer_load_dwordx4 v1, s[84:87], s28 offen offset:2048 sc1 lds
    buffer_load_dwordx4 v1, s[84:87], s28 offen offset:3072 sc1 lds
    s_mov_b32 m0, 4096
    s_add_u32 s28, s52, 4096
    buffer_load_dwordx4 v1, s[84:87], s28 offen offset:0 sc1 lds
    buffer_load_dwordx4 v1, s[84:87], s28 offen offset:1024 sc1 lds
    buffer_load_dwordx4 v1, s[84:87], s28 offen offset:2048 sc1 lds
    buffer_load_dwordx4 v1, s[84:87], s28 offen offset:3072 sc1 lds
    s_waitcnt vmcnt(0)
    s_barrier
    s_barrier
    s_add_u32 s58, s58, 1
    s_cmp_lt_u32 s58, s50
    s_cbranch_scc1 l_max
    s_mov_b32 s52, 0
    s_mov_b32 s53, 0
    s_mov_b32 s59, 0
l_pro1:
    s_add_u32 m0, s53, 0
    s_add_u32 s28, s52, 0
    buffer_load_dwordx4 v1, s[84:87], s28 offen offset:0 sc1 lds
    buffer_load_dwordx4 v1, s[84:87], s28 offen offset:1024 sc1 lds
    buffer_load_dwordx4 v1, s[84:87], s28 offen offset:2048 sc1 lds
    buffer_load_dwordx4 v1, s[84:87], s28 offen offset:3072 sc1 lds
    s_add_u32 m0, s53, 4096
    s_add_u32 s28, s52, 4096
    buffer_load_dwordx4 v1, s[84:87], s28 offen offset:0 sc1 lds
    buffer_load_dwordx4 v1, s[84:87], s28 offen offset:1024 sc1 lds
    buffer_load_dwordx4 v1, s[84:87], s28 offen offset:2048 sc1 lds
    buffer_load_dwordx4 v1, s[84:87], s28 offen offset:3072 sc1 lds
    s_add_u32 m0, s53, 8192
    s_add_u32 s28, s52, 0
    buffer_load_dwordx4 v1, s[32:35], s28 offen offset:0 sc1 lds
    buffer_load_dwordx4 v1, s[32:35], s28 offen offset:1024 sc1 lds
    buffer_load_dwordx4 v1, s[32:35], s28 offen offset:2048 sc1 lds
    buffer_load_dwordx4 v1, s[32:35], s28 offen offset:3072 sc1 lds
    s_add_u32 m0, s53, 12288
    s_add_u32 s28, s52, 4096
    buffer_load_dwordx4 v1, s[32:35], s28 offen offset:0 sc1 lds
    buffer_load_dwordx4 v1, s[32:35], s28 offen offset:1024 sc1 lds
    buffer_load_dwordx4 v1, s[32:35], s28 offen offset:2048 sc1 lds
    buffer_load_dwordx4 v1, s[32:35], s28 offen offset:3072 sc1 lds
    s_add_u32 s52, s52, 8192
    s_add_u32 s53, s53, 16384
    s_cmp_ge_u32 s53, 147456
    s_cselect_b32 s53, 0, s53
    s_add_u32 s59, s59, 1
    s_cmp_lt_u32 s59, 5
    s_cbranch_scc1 l_pro1
    s_branch l_task
l_ok:
    s_mov_b32 s60, 0
    s_add_u32 s46, s46, 1
    s_cmp_ge_u32 s46, 2
    s_cbranch_scc1 p3_a
    s_sub_u32 s47, 15, s7
    s_cmp_eq_u32 s46, 0
    s_cselect_b32 s47, s47, s7
    s_lshl_b32 s50, s47, 2
    s_add_u32 s50, s50, 4
    s_branch l_task
p3_a:
    s_and_b32 s28, s2, 7
    s_lshl_b32 s28, s28, 1
    s_lshr_b32 s29, s2, 7
    s_add_u32 s66, s28, s29
    s_lshr_b32 s67, s2, 3
    s_and_b32 s67, s67, 15
    s_sub_u32 s45, s3, 4
    s_mov_b32 s40, 57679872
    v_mov_b32 v3, 0
    s_mov_b32 s41, 0
poll_62:
    buffer_load_dword v2, v3, s[20:23], s40 offen sc1
    s_waitcnt vmcnt(0)
    v_readfirstlane_b32 s29, v2
    s_cmp_ge_u32 s29, 64
    s_cbranch_scc1 polled_63
    s_sleep 8
    s_add_u32 s41, s41, 1
    s_cmp_lt_u32 s41, 0x100000
    s_cbranch_scc1 poll_62
polled_63:
    s_lshl_b32 s28, s45, 14
    s_add_u32 s50, s28, 33554432
    s_add_u32 s51, s28, 33619968
    s_add_u32 m0, s28, 0
    s_add_u32 s29, s50, 0
    buffer_load_dwordx4 v1, s[20:23], s29 offen offset:0 sc1 lds
    buffer_load_dwordx4 v1, s[20:23], s29 offen offset:1024 sc1 lds
    buffer_load_dwordx4 v1, s[20:23], s29 offen offset:2048 sc1 lds
    buffer_load_dwordx4 v1, s[20:23], s29 offen offset:3072 sc1 lds
    s_add_u32 m0, s28, 4096
    s_add_u32 s29, s50, 4096
    buffer_load_dwordx4 v1, s[20:23], s29 offen offset:0 sc1 lds
    buffer_load_dwordx4 v1, s[20:23], s29 offen offset:1024 sc1 lds
    buffer_load_dwordx4 v1, s[20:23], s29 offen offset:2048 sc1 lds
    buffer_load_dwordx4 v1, s[20:23], s29 offen offset:3072 sc1 lds
    s_add_u32 m0, s28, 8192
    s_add_u32 s29, s50, 8192
    buffer_load_dwordx4 v1, s[20:23], s29 offen offset:0 sc1 lds
    buffer_load_dwordx4 v1, s[20:23], s29 offen offset:1024 sc1 lds
    buffer_load_dwordx4 v1, s[20:23], s29 offen offset:2048 sc1 lds
    buffer_load_dwordx4 v1, s[20:23], s29 offen offset:3072 sc1 lds
    s_add_u32 m0, s28, 12288
    s_add_u32 s29, s50, 12288
    buffer_load_dwordx4 v1, s[20:23], s29 offen offset:0 sc1 lds
    buffer_load_dwordx4 v1, s[20:23], s29 offen offset:1024 sc1 lds
    buffer_load_dwordx4 v1, s[20:23], s29 offen offset:2048 sc1 lds
    buffer_load_dwordx4 v1, s[20:23], s29 offen offset:3072 sc1 lds
    s_add_u32 m0, s28, 65536
    s_add_u32 s29, s51, 0
    buffer_load_dwordx4 v1, s[20:23], s29 offen offset:0 sc1 lds
    buffer_load_dwordx4 v1, s[20:23], s29 offen offset:1024 sc1 lds
    buffer_load_dwordx4 v1, s[20:23], s29 offen offset:2048 sc1 lds
    buffer_load_dwordx4 v1, s[20:23], s29 offen offset:3072 sc1 lds
    s_add_u32 m0, s28, 69632
    s_add_u32 s29, s51, 4096
    buffer_load_dwordx4 v1, s[20:23], s29 offen offset:0 sc1 lds
    buffer_load_dwordx4 v1, s[20:23], s29 offen offset:1024 sc1 lds
    buffer_load_dwordx4 v1, s[20:23], s29 offen offset:2048 sc1 lds
    buffer_load_dwordx4 v1, s[20:23], s29 offen offset:3072 sc1 lds
    s_add_u32 m0, s28, 73728
    s_add_u32 s29, s51, 8192
    buffer_load_dwordx4 v1, s[20:23], s29 offen offset:0 sc1 lds
    buffer_load_dwordx4 v1, s[20:23], s29 offen offset:1024 sc1 lds
    buffer_load_dwordx4 v1, s[20:23], s29 offen offset:2048 sc1 lds
    buffer_load_dwordx4 v1, s[20:23], s29 offen offset:3072 sc1 lds
    s_add_u32 m0, s28, 77824
    s_add_u32 s29, s51, 12288
    buffer_load_dwordx4 v1, s[20:23], s29 offen offset:0 sc1 lds
    buffer_load_dwordx4 v1, s[20:23], s29 offen offset:1024 sc1 lds
    buffer_load_dwordx4 v1, s[20:23], s29 offen offset:2048 sc1 lds
    buffer_load_dwordx4 v1, s[20:23], s29 offen offset:3072 sc1 lds
    s_lshl_b32 s28, s2, 13
    s_lshl_b32 s29, s45, 11
    s_add_u32 s29, s29, s28
    s_add_u32 s29, s29, 73400320
    buffer_load_dwordx4 v[8:11], v1, s[20:23], s29 offen sc1
    buffer_load_dwordx4 v[12:15], v1, s[20:23], s29 offen offset:1024 sc1
    s_lshl_b32 s48, s66, 7
    s_lshl_b32 s29, s45, 5
    s_add_u32 s48, s48, s29
    v_and_b32 v3, 31, v0
    v_lshrrev_b32 v4, 5, v0
    v_add_u32 v2, s48, v3
    v_lshlrev_b32 v2, 3, v2
    s_mov_b32 s28, 33816576
    buffer_load_dword v160, v2, s[20:23], s28 offen sc1
    v_lshl_add_u32 v7, v4, 4, v3
    v_lshlrev_b32 v7, 4, v7
    v_add_u32 v7, 0x10000, v7
    v_mov_b32 v2, 0x3f803f80
    v_cmp_eq_u32 vcc, 16, v3
    s_nop 1
    v_cndmask_b32 v2, 0, v2, vcc
    v_cmp_gt_u32 s[62:63], 16, v3
    s_mov_b32 s60, 0
    v_mov_b32 v132, v2
    v_mov_b32 v133, v2
    v_mov_b32 v134, v2
    v_mov_b32 v135, v2
    v_mov_b32 v136, v2
    v_mov_b32 v137, v2
    v_mov_b32 v138, v2
    v_mov_b32 v139, v2
    v_mov_b32 v144, v2
    v_mov_b32 v145, v2
    v_mov_b32 v146, v2
    v_mov_b32 v147, v2
    v_mov_b32 v148, v2
    v_mov_b32 v149, v2
    v_mov_b32 v150, v2
    v_mov_b32 v151, v2
    s_waitcnt vmcnt(0)
    s_barrier
    s_setprio 3
p3a_start:
    v_mov_b32 v5, v1
    v_mov_b32 v6, v7
    ds_read_b128 v[140:143], v5
    ds_read_b128 v[128:131], v5 offset:1024
    s_mov_b64 exec, s[62:63]
    ds_read_b128 v[132:135], v6 offset:0
    ds_read_b128 v[136:139], v6 offset:512
    s_mov_b64 exec, -1
    v_mov_b32 v64, 0
    v_mov_b32 v65, 0
    v_mov_b32 v66, 0
    v_mov_b32 v67, 0
    v_mov_b32 v68, 0
    v_mov_b32 v69, 0
    v_mov_b32 v70, 0
    v_mov_b32 v71, 0
    v_mov_b32 v72, 0
    v_mov_b32 v73, 0
    v_mov_b32 v74, 0
    v_mov_b32 v75, 0
    v_mov_b32 v76, 0
    v_mov_b32 v77, 0
    v_mov_b32 v78, 0
    v_mov_b32 v79, 0
    v_mov_b32 v80, 0
    v_mov_b32 v81, 0
    v_mov_b32 v82, 0
    v_mov_b32 v83, 0
    v_mov_b32 v84, 0
    v_mov_b32 v85, 0
    v_mov_b32 v86, 0
    v_mov_b32 v87, 0
    v_mov_b32 v88, 0
    v_mov_b32 v89, 0
    v_mov_b32 v90, 0
    v_mov_b32 v91, 0
    v_mov_b32 v92, 0
    v_mov_b32 v93, 0
    v_mov_b32 v94, 0
    v_mov_b32 v95, 0
    s_waitcnt lgkmcnt(3)
    s_cmp_eq_u32 s60, 0
    s_cbranch_scc1 p3a_raw
    v_mfma_f32_32x32x16_bf16 v[96:111], v[140:143], v[8:11], v[32:47]
    v_mfma_f32_32x32x16_bf16 v[112:127], v[140:143], v[12:15], v[48:63]
    s_nop 15
    s_branch p3a_go
p3a_raw:
    v_mfma_f32_32x32x16_bf16 v[96:111], v[140:143], v[8:11], 0
    v_mfma_f32_32x32x16_bf16 v[112:127], v[140:143], v[12:15], 0
    s_nop 15
    v_max3_f32 v2, v96, v97, v98
    v_max3_f32 v2, v2, v99, v100
    v_max3_f32 v2, v2, v101, v102
    v_max3_f32 v2, v2, v103, v104
    v_max3_f32 v2, v2, v105, v106
    v_max3_f32 v2, v2, v107, v108
    v_max3_f32 v2, v2, v109, v110
    v_max_f32 v2, v2, v111
    v_mov_b32 v161, v2
    s_nop 1
    v_permlane32_swap_b32 v161, v2
    s_nop 1
    v_max_f32 v2, v2, v161
    v_sub_f32 v96, v96, v2
    v_sub_f32 v97, v97, v2
    v_sub_f32 v98, v98, v2
    v_sub_f32 v99, v99, v2
    v_sub_f32 v100, v100, v2
    v_sub_f32 v101, v101, v2
    v_sub_f32 v102, v102, v2
    v_sub_f32 v103, v103, v2
    v_sub_f32 v104, v104, v2
    v_sub_f32 v105, v105, v2
    v_sub_f32 v106, v106, v2
    v_sub_f32 v107, v107, v2
    v_sub_f32 v108, v108, v2
    v_sub_f32 v109, v109, v2
    v_sub_f32 v110, v110, v2
    v_sub_f32 v111, v111, v2
    v_sub_f32 v32, 0, v2
    v_sub_f32 v33, 0, v2
    v_sub_f32 v34, 0, v2
    v_sub_f32 v35, 0, v2
    v_sub_f32 v36, 0, v2
    v_sub_f32 v37, 0, v2
    v_sub_f32 v38, 0, v2
    v_sub_f32 v39, 0, v2
    v_sub_f32 v40, 0, v2
    v_sub_f32 v41, 0, v2
    v_sub_f32 v42, 0, v2
    v_sub_f32 v43, 0, v2
    v_sub_f32 v44, 0, v2
    v_sub_f32 v45, 0, v2
    v_sub_f32 v46, 0, v2
    v_sub_f32 v47, 0, v2
    v_max3_f32 v2, v112, v113, v114
    v_max3_f32 v2, v2, v115, v116
    v_max3_f32 v2, v2, v117, v118
    v_max3_f32 v2, v2, v119, v120
    v_max3_f32 v2, v2, v121, v122
    v_max3_f32 v2, v2, v123, v124
    v_max3_f32 v2, v2, v125, v126
    v_max_f32 v2, v2, v127
    v_mov_b32 v161, v2
    s_nop 1
    v_permlane32_swap_b32 v161, v2
    s_nop 1
    v_max_f32 v2, v2, v161
    v_sub_f32 v112, v112, v2
    v_sub_f32 v113, v113, v2
    v_sub_f32 v114, v114, v2
    v_sub_f32 v115, v115, v2
    v_sub_f32 v116, v116, v2
    v_sub_f32 v117, v117, v2
    v_sub_f32 v118, v118, v2
    v_sub_f32 v119, v119, v2
    v_sub_f32 v120, v120, v2
    v_sub_f32 v121, v121, v2
    v_sub_f32 v122, v122, v2
    v_sub_f32 v123, v123, v2
    v_sub_f32 v124, v124, v2
    v_sub_f32 v125, v125, v2
    v_sub_f32 v126, v126, v2
    v_sub_f32 v127, v127, v2
    v_sub_f32 v48, 0, v2
    v_sub_f32 v49, 0, v2
    v_sub_f32 v50, 0, v2
    v_sub_f32 v51, 0, v2
    v_sub_f32 v52, 0, v2
    v_sub_f32 v53, 0, v2
    v_sub_f32 v54, 0, v2
    v_sub_f32 v55, 0, v2
    v_sub_f32 v56, 0, v2
    v_sub_f32 v57, 0, v2
    v_sub_f32 v58, 0, v2
    v_sub_f32 v59, 0, v2
    v_sub_f32 v60, 0, v2
    v_sub_f32 v61, 0, v2
    v_sub_f32 v62, 0, v2
    v_sub_f32 v63, 0, v2
p3a_go:
    s_mov_b32 s52, 0
    v_exp_f32 v96, v96
    v_exp_f32 v97, v97
    v_exp_f32 v98, v98
    v_cvt_pk_bf16_f32 v16, v96, v97
    v_exp_f32 v99, v99
    v_exp_f32 v100, v100
    v_cvt_pk_bf16_f32 v17, v98, v99
    v_exp_f32 v101, v101
    v_exp_f32 v102, v102
    v_cvt_pk_bf16_f32 v18, v100, v101
    v_exp_f32 v103, v103
    v_exp_f32 v104, v104
    v_cvt_pk_bf16_f32 v19, v102, v103
    v_exp_f32 v105, v105
    v_exp_f32 v106, v106
    v_cvt_pk_bf16_f32 v20, v104, v105
    v_exp_f32 v107, v107
    v_exp_f32 v108, v108
    v_cvt_pk_bf16_f32 v21, v106, v107
    v_exp_f32 v109, v109
    v_exp_f32 v110, v110
    v_cvt_pk_bf16_f32 v22, v108, v109
    v_exp_f32 v111, v111
    s_nop 0
    v_cvt_pk_bf16_f32 v23, v110, v111
p3a_loop:
    s_waitcnt lgkmcnt(0)
    v_mfma_f32_32x32x16_bf16 v[96:111], v[128:131], v[8:11], v[32:47]
    ds_read_b128 v[140:143], v5 offset:2048
    s_mov_b64 exec, s[62:63]
    ds_read_b128 v[144:147], v6 offset:1024
    ds_read_b128 v[148:151], v6 offset:1536
    s_mov_b64 exec, -1
    v_exp_f32 v112, v112
    v_exp_f32 v113, v113
    v_exp_f32 v114, v114
    v_cvt_pk_bf16_f32 v24, v112, v113
    v_exp_f32 v115, v115
    v_mfma_f32_32x32x16_bf16 v[64:79], v[132:135], v[16:19], v[64:79]
    v_exp_f32 v116, v116
    v_cvt_pk_bf16_f32 v25, v114, v115
    v_exp_f32 v117, v117
    v_exp_f32 v118, v118
    v_cvt_pk_bf16_f32 v26, v116, v117
    v_exp_f32 v119, v119
    v_mfma_f32_32x32x16_bf16 v[64:79], v[136:139], v[20:23], v[64:79]
    v_exp_f32 v120, v120
    v_cvt_pk_bf16_f32 v27, v118, v119
    v_exp_f32 v121, v121
    v_exp_f32 v122, v122
    v_cvt_pk_bf16_f32 v28, v120, v121
    v_exp_f32 v123, v123
    v_exp_f32 v124, v124
    v_cvt_pk_bf16_f32 v29, v122, v123
    v_exp_f32 v125, v125
    v_exp_f32 v126, v126
    v_cvt_pk_bf16_f32 v30, v124, v125
    v_exp_f32 v127, v127
    s_nop 0
    v_cvt_pk_bf16_f32 v31, v126, v127
    v_mfma_f32_32x32x16_bf16 v[112:127], v[128:131], v[12:15], v[48:63]
    v_exp_f32 v96, v96
    v_exp_f32 v97, v97
    v_exp_f32 v98, v98
    v_cvt_pk_bf16_f32 v16, v96, v97
    v_exp_f32 v99, v99
    v_mfma_f32_32x32x16_bf16 v[80:95], v[132:135], v[24:27], v[80:95]
    v_exp_f32 v100, v100
    v_cvt_pk_bf16_f32 v17, v98, v99
    v_exp_f32 v101, v101
    v_exp_f32 v102, v102
    v_cvt_pk_bf16_f32 v18, v100, v101
    v_exp_f32 v103, v103
    v_mfma_f32_32x32x16_bf16 v[80:95], v[136:139], v[28:31], v[80:95]
    v_exp_f32 v104, v104
    v_cvt_pk_bf16_f32 v19, v102, v103
    v_exp_f32 v105, v105
    v_exp_f32 v106, v106
    v_cvt_pk_bf16_f32 v20, v104, v105
    v_exp_f32 v107, v107
    v_exp_f32 v108, v108
    v_cvt_pk_bf16_f32 v21, v106, v107
    v_exp_f32 v109, v109
    v_exp_f32 v110, v110
    v_cvt_pk_bf16_f32 v22, v108, v109
    v_exp_f32 v111, v111
    s_nop 0
    v_cvt_pk_bf16_f32 v23, v110, v111
    s_waitcnt lgkmcnt(0)
    v_mfma_f32_32x32x16_bf16 v[96:111], v[140:143], v[8:11], v[32:47]
    ds_read_b128 v[128:131], v5 offset:3072
    s_mov_b64 exec, s[62:63]
    ds_read_b128 v[132:135], v6 offset:2048
    ds_read_b128 v[136:139], v6 offset:2560
    s_mov_b64 exec, -1
    v_exp_f32 v112, v112
    v_exp_f32 v113, v113
    v_exp_f32 v114, v114
    v_cvt_pk_bf16_f32 v24, v112, v113
    v_exp_f32 v115, v115
    v_mfma_f32_32x32x16_bf16 v[64:79], v[144:147], v[16:19], v[64:79]
    v_exp_f32 v116, v116
    v_cvt_pk_bf16_f32 v25, v114, v115
    v_exp_f32 v117, v117
    v_exp_f32 v118, v118
    v_cvt_pk_bf16_f32 v26, v116, v117
    v_exp_f32 v119, v119
    v_mfma_f32_32x32x16_bf16 v[64:79], v[148:151], v[20:23], v[64:79]
    v_exp_f32 v120, v120
    v_cvt_pk_bf16_f32 v27, v118, v119
    v_exp_f32 v121, v121
    v_exp_f32 v122, v122
    v_cvt_pk_bf16_f32 v28, v120, v121
    v_exp_f32 v123, v123
    v_exp_f32 v124, v124
    v_cvt_pk_bf16_f32 v29, v122, v123
    v_exp_f32 v125, v125
    v_exp_f32 v126, v126
    v_cvt_pk_bf16_f32 v30, v124, v125
    v_exp_f32 v127, v127
    s_nop 0
    v_cvt_pk_bf16_f32 v31, v126, v127
    v_mfma_f32_32x32x16_bf16 v[112:127], v[140:143], v[12:15], v[48:63]
    v_exp_f32 v96, v96
    v_exp_f32 v97, v97
    v_exp_f32 v98, v98
    v_cvt_pk_bf16_f32 v16, v96, v97
    v_exp_f32 v99, v99
    v_mfma_f32_32x32x16_bf16 v[80:95], v[144:147], v[24:27], v[80:95]
    v_exp_f32 v100, v100
    v_cvt_pk_bf16_f32 v17, v98, v99
    v_exp_f32 v101, v101
    v_exp_f32 v102, v102
    v_cvt_pk_bf16_f32 v18, v100, v101
    v_exp_f32 v103, v103
    v_mfma_f32_32x32x16_bf16 v[80:95], v[148:151], v[28:31], v[80:95]
    v_exp_f32 v104, v104
    v_cvt_pk_bf16_f32 v19, v102, v103
    v_exp_f32 v105, v105
    v_exp_f32 v106, v106
    v_cvt_pk_bf16_f32 v20, v104, v105
    v_exp_f32 v107, v107
    v_exp_f32 v108, v108
    v_cvt_pk_bf16_f32 v21, v106, v107
    v_exp_f32 v109, v109
    v_exp_f32 v110, v110
    v_cvt_pk_bf16_f32 v22, v108, v109
    v_exp_f32 v111, v111
    s_nop 0
    v_cvt_pk_bf16_f32 v23, v110, v111
    s_waitcnt lgkmcnt(0)
    v_mfma_f32_32x32x16_bf16 v[96:111], v[128:131], v[8:11], v[32:47]
    ds_read_b128 v[140:143], v5 offset:4096
    s_mov_b64 exec, s[62:63]
    ds_read_b128 v[144:147], v6 offset:3072
    ds_read_b128 v[148:151], v6 offset:3584
    s_mov_b64 exec, -1
    v_exp_f32 v112, v112
    v_exp_f32 v113, v113
    v_exp_f32 v114, v114
    v_cvt_pk_bf16_f32 v24, v112, v113
    v_exp_f32 v115, v115
    v_mfma_f32_32x32x16_bf16 v[64:79], v[132:135], v[16:19], v[64:79]
    v_exp_f32 v116, v116
    v_cvt_pk_bf16_f32 v25, v114, v115
    v_exp_f32 v117, v117
    v_exp_f32 v118, v118
    v_cvt_pk_bf16_f32 v26, v116, v117
    v_exp_f32 v119, v119
    v_mfma_f32_32x32x16_bf16 v[64:79], v[136:139], v[20:23], v[64:79]
    v_exp_f32 v120, v120
    v_cvt_pk_bf16_f32 v27, v118, v119
    v_exp_f32 v121, v121
    v_exp_f32 v122, v122
    v_cvt_pk_bf16_f32 v28, v120, v121
    v_exp_f32 v123, v123
    v_exp_f32 v124, v124
    v_cvt_pk_bf16_f32 v29, v122, v123
    v_exp_f32 v125, v125
    v_exp_f32 v126, v126
    v_cvt_pk_bf16_f32 v30, v124, v125
    v_exp_f32 v127, v127
    s_nop 0
    v_cvt_pk_bf16_f32 v31, v126, v127
    v_mfma_f32_32x32x16_bf16 v[112:127], v[128:131], v[12:15], v[48:63]
    v_exp_f32 v96, v96
    v_exp_f32 v97, v97
    v_exp_f32 v98, v98
    v_cvt_pk_bf16_f32 v16, v96, v97
    v_exp_f32 v99, v99
    v_mfma_f32_32x32x16_bf16 v[80:95], v[132:135], v[24:27], v[80:95]
    v_exp_f32 v100, v100
    v_cvt_pk_bf16_f32 v17, v98, v99
    v_exp_f32 v101, v101
    v_exp_f32 v102, v102
    v_cvt_pk_bf16_f32 v18, v100, v101
    v_exp_f32 v103, v103
    v_mfma_f32_32x32x16_bf16 v[80:95], v[136:139], v[28:31], v[80:95]
    v_exp_f32 v104, v104
    v_cvt_pk_bf16_f32 v19, v102, v103
    v_exp_f32 v105, v105
    v_exp_f32 v106, v106
    v_cvt_pk_bf16_f32 v20, v104, v105
    v_exp_f32 v107, v107
    v_exp_f32 v108, v108
    v_cvt_pk_bf16_f32 v21, v106, v107
    v_exp_f32 v109, v109
    v_exp_f32 v110, v110
    v_cvt_pk_bf16_f32 v22, v108, v109
    v_exp_f32 v111, v111
    s_nop 0
    v_cvt_pk_bf16_f32 v23, v110, v111
    s_waitcnt lgkmcnt(0)
    v_mfma_f32_32x32x16_bf16 v[96:111], v[140:143], v[8:11], v[32:47]
    ds_read_b128 v[128:131], v5 offset:5120
    s_mov_b64 exec, s[62:63]
    ds_read_b128 v[132:135], v6 offset:4096
    ds_read_b128 v[136:139], v6 offset:4608
    s_mov_b64 exec, -1
    v_exp_f32 v112, v112
    v_exp_f32 v113, v113
    v_exp_f32 v114, v114
    v_cvt_pk_bf16_f32 v24, v112, v113
    v_exp_f32 v115, v115
    v_mfma_f32_32x32x16_bf16 v[64:79], v[144:147], v[16:19], v[64:79]
    v_exp_f32 v116, v116
    v_cvt_pk_bf16_f32 v25, v114, v115
    v_exp_f32 v117, v117
    v_exp_f32 v118, v118
    v_cvt_pk_bf16_f32 v26, v116, v117
    v_exp_f32 v119, v119
    v_mfma_f32_32x32x16_bf16 v[64:79], v[148:151], v[20:23], v[64:79]
    v_exp_f32 v120, v120
    v_cvt_pk_bf16_f32 v27, v118, v119
    v_exp_f32 v121, v121
    v_exp_f32 v122, v122
    v_cvt_pk_bf16_f32 v28, v120, v121
    v_exp_f32 v123, v123
    v_exp_f32 v124, v124
    v_cvt_pk_bf16_f32 v29, v122, v123
    v_exp_f32 v125, v125
    v_exp_f32 v126, v126
    v_cvt_pk_bf16_f32 v30, v124, v125
    v_exp_f32 v127, v127
    s_nop 0
    v_cvt_pk_bf16_f32 v31, v126, v127
    v_mfma_f32_32x32x16_bf16 v[112:127], v[140:143], v[12:15], v[48:63]
    v_exp_f32 v96, v96
    v_exp_f32 v97, v97
    v_exp_f32 v98, v98
    v_cvt_pk_bf16_f32 v16, v96, v97
    v_exp_f32 v99, v99
    v_mfma_f32_32x32x16_bf16 v[80:95], v[144:147], v[24:27], v[80:95]
    v_exp_f32 v100, v100
    v_cvt_pk_bf16_f32 v17, v98, v99
    v_exp_f32 v101, v101
    v_exp_f32 v102, v102
    v_cvt_pk_bf16_f32 v18, v100, v101
    v_exp_f32 v103, v103
    v_mfma_f32_32x32x16_bf16 v[80:95], v[148:151], v[28:31], v[80:95]
    v_exp_f32 v104, v104
    v_cvt_pk_bf16_f32 v19, v102, v103
    v_exp_f32 v105, v105
    v_exp_f32 v106, v106
    v_cvt_pk_bf16_f32 v20, v104, v105
    v_exp_f32 v107, v107
    v_exp_f32 v108, v108
    v_cvt_pk_bf16_f32 v21, v106, v107
    v_exp_f32 v109, v109
    v_exp_f32 v110, v110
    v_cvt_pk_bf16_f32 v22, v108, v109
    v_exp_f32 v111, v111
    s_nop 0
    v_cvt_pk_bf16_f32 v23, v110, v111
    s_waitcnt lgkmcnt(0)
    v_mfma_f32_32x32x16_bf16 v[96:111], v[128:131], v[8:11], v[32:47]
    ds_read_b128 v[140:143], v5 offset:6144
    s_mov_b64 exec, s[62:63]
    ds_read_b128 v[144:147], v6 offset:5120
    ds_read_b128 v[148:151], v6 offset:5632
    s_mov_b64 exec, -1
    v_exp_f32 v112, v112
    v_exp_f32 v113, v113
    v_exp_f32 v114, v114
    v_cvt_pk_bf16_f32 v24, v112, v113
    v_exp_f32 v115, v115
    v_mfma_f32_32x32x16_bf16 v[64:79], v[132:135], v[16:19], v[64:79]
    v_exp_f32 v116, v116
    v_cvt_pk_bf16_f32 v25, v114, v115
    v_exp_f32 v117, v117
    v_exp_f32 v118, v118
    v_cvt_pk_bf16_f32 v26, v116, v117
    v_exp_f32 v119, v119
    v_mfma_f32_32x32x16_bf16 v[64:79], v[136:139], v[20:23], v[64:79]
    v_exp_f32 v120, v120
    v_cvt_pk_bf16_f32 v27, v118, v119
    v_exp_f32 v121, v121
    v_exp_f32 v122, v122
    v_cvt_pk_bf16_f32 v28, v120, v121
    v_exp_f32 v123, v123
    v_exp_f32 v124, v124
    v_cvt_pk_bf16_f32 v29, v122, v123
    v_exp_f32 v125, v125
    v_exp_f32 v126, v126
    v_cvt_pk_bf16_f32 v30, v124, v125
    v_exp_f32 v127, v127
    s_nop 0
    v_cvt_pk_bf16_f32 v31, v126, v127
    v_mfma_f32_32x32x16_bf16 v[112:127], v[128:131], v[12:15], v[48:63]
    v_exp_f32 v96, v96
    v_exp_f32 v97, v97
    v_exp_f32 v98, v98
    v_cvt_pk_bf16_f32 v16, v96, v97
    v_exp_f32 v99, v99
    v_mfma_f32_32x32x16_bf16 v[80:95], v[132:135], v[24:27], v[80:95]
    v_exp_f32 v100, v100
    v_cvt_pk_bf16_f32 v17, v98, v99
    v_exp_f32 v101, v101
    v_exp_f32 v102, v102
    v_cvt_pk_bf16_f32 v18, v100, v101
    v_exp_f32 v103, v103
    v_mfma_f32_32x32x16_bf16 v[80:95], v[136:139], v[28:31], v[80:95]
    v_exp_f32 v104, v104
    v_cvt_pk_bf16_f32 v19, v102, v103
    v_exp_f32 v105, v105
    v_exp_f32 v106, v106
    v_cvt_pk_bf16_f32 v20, v104, v105
    v_exp_f32 v107, v107
    v_exp_f32 v108, v108
    v_cvt_pk_bf16_f32 v21, v106, v107
    v_exp_f32 v109, v109
    v_exp_f32 v110, v110
    v_cvt_pk_bf16_f32 v22, v108, v109
    v_exp_f32 v111, v111
    s_nop 0
    v_cvt_pk_bf16_f32 v23, v110, v111
    s_waitcnt lgkmcnt(0)
    v_mfma_f32_32x32x16_bf16 v[96:111], v[140:143], v[8:11], v[32:47]
    ds_read_b128 v[128:131], v5 offset:7168
    s_mov_b64 exec, s[62:63]
    ds_read_b128 v[132:135], v6 offset:6144
    ds_read_b128 v[136:139], v6 offset:6656
    s_mov_b64 exec, -1
    v_exp_f32 v112, v112
    v_exp_f32 v113, v113
    v_exp_f32 v114, v114
    v_cvt_pk_bf16_f32 v24, v112, v113
    v_exp_f32 v115, v115
    v_mfma_f32_32x32x16_bf16 v[64:79], v[144:147], v[16:19], v[64:79]
    v_exp_f32 v116, v116
    v_cvt_pk_bf16_f32 v25, v114, v115
    v_exp_f32 v117, v117
    v_exp_f32 v118, v118
    v_cvt_pk_bf16_f32 v26, v116, v117
    v_exp_f32 v119, v119
    v_mfma_f32_32x32x16_bf16 v[64:79], v[148:151], v[20:23], v[64:79]
    v_exp_f32 v120, v120
    v_cvt_pk_bf16_f32 v27, v118, v119
    v_exp_f32 v121, v121
    v_exp_f32 v122, v122
    v_cvt_pk_bf16_f32 v28, v120, v121
    v_exp_f32 v123, v123
    v_exp_f32 v124, v124
    v_cvt_pk_bf16_f32 v29, v122, v123
    v_exp_f32 v125, v125
    v_exp_f32 v126, v126
    v_cvt_pk_bf16_f32 v30, v124, v125
    v_exp_f32 v127, v127
    s_nop 0
    v_cvt_pk_bf16_f32 v31, v126, v127
    v_mfma_f32_32x32x16_bf16 v[112:127], v[140:143], v[12:15], v[48:63]
    v_exp_f32 v96, v96
    v_exp_f32 v97, v97
    v_exp_f32 v98, v98
    v_cvt_pk_bf16_f32 v16, v96, v97
    v_exp_f32 v99, v99
    v_mfma_f32_32x32x16_bf16 v[80:95], v[144:147], v[24:27], v[80:95]
    v_exp_f32 v100, v100
    v_cvt_pk_bf16_f32 v17, v98, v99
    v_exp_f32 v101, v101
    v_exp_f32 v102, v102
    v_cvt_pk_bf16_f32 v18, v100, v101
    v_exp_f32 v103, v103
    v_mfma_f32_32x32x16_bf16 v[80:95], v[148:151], v[28:31], v[80:95]
    v_exp_f32 v104, v104
    v_cvt_pk_bf16_f32 v19, v102, v103
    v_exp_f32 v105, v105
    v_exp_f32 v106, v106
    v_cvt_pk_bf16_f32 v20, v104, v105
    v_exp_f32 v107, v107
    v_exp_f32 v108, v108
    v_cvt_pk_bf16_f32 v21, v106, v107
    v_exp_f32 v109, v109
    v_exp_f32 v110, v110
    v_cvt_pk_bf16_f32 v22, v108, v109
    v_exp_f32 v111, v111
    s_nop 0
    v_cvt_pk_bf16_f32 v23, v110, v111
    s_waitcnt lgkmcnt(0)
    v_mfma_f32_32x32x16_bf16 v[96:111], v[128:131], v[8:11], v[32:47]
    ds_read_b128 v[140:143], v5 offset:8192
    s_mov_b64 exec, s[62:63]
    ds_read_b128 v[144:147], v6 offset:7168
    ds_read_b128 v[148:151], v6 offset:7680
    s_mov_b64 exec, -1
    v_exp_f32 v112, v112
    v_exp_f32 v113, v113
    v_exp_f32 v114, v114
    v_cvt_pk_bf16_f32 v24, v112, v113
    v_exp_f32 v115, v115
    v_mfma_f32_32x32x16_bf16 v[64:79], v[132:135], v[16:19], v[64:79]
    v_exp_f32 v116, v116
    v_cvt_pk_bf16_f32 v25, v114, v115
    v_exp_f32 v117, v117
    v_exp_f32 v118, v118
    v_cvt_pk_bf16_f32 v26, v116, v117
    v_exp_f32 v119, v119
    v_mfma_f32_32x32x16_bf16 v[64:79], v[136:139], v[20:23], v[64:79]
    v_exp_f32 v120, v120
    v_cvt_pk_bf16_f32 v27, v118, v119
    v_exp_f32 v121, v121
    v_exp_f32 v122, v122
    v_cvt_pk_bf16_f32 v28, v120, v121
    v_exp_f32 v123, v123
    v_exp_f32 v124, v124
    v_cvt_pk_bf16_f32 v29, v122, v123
    v_exp_f32 v125, v125
    v_exp_f32 v126, v126
    v_cvt_pk_bf16_f32 v30, v124, v125
    v_exp_f32 v127, v127
    s_nop 0
    v_cvt_pk_bf16_f32 v31, v126, v127
    v_mfma_f32_32x32x16_bf16 v[112:127], v[128:131], v[12:15], v[48:63]
    v_exp_f32 v96, v96
    v_exp_f32 v97, v97
    v_exp_f32 v98, v98
    v_cvt_pk_bf16_f32 v16, v96, v97
    v_exp_f32 v99, v99
    v_mfma_f32_32x32x16_bf16 v[80:95], v[132:135], v[24:27], v[80:95]
    v_exp_f32 v100, v100
    v_cvt_pk_bf16_f32 v17, v98, v99
    v_exp_f32 v101, v101
    v_exp_f32 v102, v102
    v_cvt_pk_bf16_f32 v18, v100, v101
    v_exp_f32 v103, v103
    v_mfma_f32_32x32x16_bf16 v[80:95], v[136:139], v[28:31], v[80:95]
    v_exp_f32 v104, v104
    v_cvt_pk_bf16_f32 v19, v102, v103
    v_exp_f32 v105, v105
    v_exp_f32 v106, v106
    v_cvt_pk_bf16_f32 v20, v104, v105
    v_exp_f32 v107, v107
    v_exp_f32 v108, v108
    v_cvt_pk_bf16_f32 v21, v106, v107
    v_exp_f32 v109, v109
    v_exp_f32 v110, v110
    v_cvt_pk_bf16_f32 v22, v108, v109
    v_exp_f32 v111, v111
    s_nop 0
    v_cvt_pk_bf16_f32 v23, v110, v111
    s_waitcnt lgkmcnt(0)
    v_mfma_f32_32x32x16_bf16 v[96:111], v[140:143], v[8:11], v[32:47]
    ds_read_b128 v[128:131], v5 offset:9216
    s_mov_b64 exec, s[62:63]
    ds_read_b128 v[132:135], v6 offset:8192
    ds_read_b128 v[136:139], v6 offset:8704
    s_mov_b64 exec, -1
    v_exp_f32 v112, v112
    v_exp_f32 v113, v113
    v_exp_f32 v114, v114
    v_cvt_pk_bf16_f32 v24, v112, v113
    v_exp_f32 v115, v115
    v_mfma_f32_32x32x16_bf16 v[64:79], v[144:147], v[16:19], v[64:79]
    v_exp_f32 v116, v116
    v_cvt_pk_bf16_f32 v25, v114, v115
    v_exp_f32 v117, v117
    v_exp_f32 v118, v118
    v_cvt_pk_bf16_f32 v26, v116, v117
    v_exp_f32 v119, v119
    v_mfma_f32_32x32x16_bf16 v[64:79], v[148:151], v[20:23], v[64:79]
    v_exp_f32 v120, v120
    v_cvt_pk_bf16_f32 v27, v118, v119
    v_exp_f32 v121, v121
    v_exp_f32 v122, v122
    v_cvt_pk_bf16_f32 v28, v120, v121
    v_exp_f32 v123, v123
    v_exp_f32 v124, v124
    v_cvt_pk_bf16_f32 v29, v122, v123
    v_exp_f32 v125, v125
    v_exp_f32 v126, v126
    v_cvt_pk_bf16_f32 v30, v124, v125
    v_exp_f32 v127, v127
    s_nop 0
    v_cvt_pk_bf16_f32 v31, v126, v127
    v_mfma_f32_32x32x16_bf16 v[112:127], v[140:143], v[12:15], v[48:63]
    v_exp_f32 v96, v96
    v_exp_f32 v97, v97
    v_add_u32 v5, 0x2000, v5
    v_exp_f32 v98, v98
    v_add_u32 v6, 0x2000, v6
    v_cvt_pk_bf16_f32 v16, v96, v97
    s_add_u32 s52, s52, 1
    v_exp_f32 v99, v99
    s_cmp_lt_u32 s52, 8
    v_mfma_f32_32x32x16_bf16 v[80:95], v[144:147], v[24:27], v[80:95]
    v_exp_f32 v100, v100
    v_cvt_pk_bf16_f32 v17, v98, v99
    v_exp_f32 v101, v101
    v_exp_f32 v102, v102
    v_cvt_pk_bf16_f32 v18, v100, v101
    v_exp_f32 v103, v103
    v_mfma_f32_32x32x16_bf16 v[80:95], v[148:151], v[28:31], v[80:95]
    v_exp_f32 v104, v104
    v_cvt_pk_bf16_f32 v19, v102, v103
    v_exp_f32 v105, v105
    v_exp_f32 v106, v106
    v_cvt_pk_bf16_f32 v20, v104, v105
    v_exp_f32 v107, v107
    v_exp_f32 v108, v108
    v_cvt_pk_bf16_f32 v21, v106, v107
    v_exp_f32 v109, v109
    v_exp_f32 v110, v110
    v_cvt_pk_bf16_f32 v22, v108, v109
    v_exp_f32 v111, v111
    s_nop 0
    v_cvt_pk_bf16_f32 v23, v110, v111
    s_cbranch_scc1 p3a_loop
    s_waitcnt lgkmcnt(0)
    s_nop 15
    v_lshlrev_b32 v5, 2, v3
    ds_bpermute_b32 v6, v5, v72
    ds_bpermute_b32 v161, v5, v88
    v_mov_b32 v4, 0
    v_fma_f32 v4, v64, 0, v4
    v_fma_f32 v4, v65, 0, v4
    v_fma_f32 v4, v66, 0, v4
    v_fma_f32 v4, v67, 0, v4
    v_fma_f32 v4, v68, 0, v4
    v_fma_f32 v4, v69, 0, v4
    v_fma_f32 v4, v70, 0, v4
    v_fma_f32 v4, v71, 0, v4
    v_fma_f32 v4, v80, 0, v4
    v_fma_f32 v4, v81, 0, v4
    v_fma_f32 v4, v82, 0, v4
    v_fma_f32 v4, v83, 0, v4
    v_fma_f32 v4, v84, 0, v4
    v_fma_f32 v4, v85, 0, v4
    v_fma_f32 v4, v86, 0, v4
    v_fma_f32 v4, v87, 0, v4
    s_mov_b32 s28, 0x5d800000
    s_waitcnt lgkmcnt(0)
    v_cmp_nle_f32 vcc, v6, s28
    v_cmp_nle_f32 s[56:57], v161, s28
    s_or_b64 s[56:57], s[56:57], vcc
    v_cmp_u_f32 vcc, v4, v4
    s_or_b64 s[56:57], s[56:57], vcc
    s_cmp_eq_u64 s[56:57], 0
    s_cbranch_scc1 p3a_ok
    s_cmp_lg_u32 s60, 0
    s_cbranch_scc1 p3a_ok
    s_mov_b32 s60, 1
    s_mov_b32 s52, 0
    v_mov_b32 v5, v1
    v_mov_b32 v162, 0xff800000
    v_mov_b32 v163, 0xff800000
p3a_max:
    ds_read_b128 v[128:131], v5
    v_add_u32 v5, 0x400, v5
    s_waitcnt lgkmcnt(0)
    v_mfma_f32_32x32x16_bf16 v[96:111], v[128:131], v[8:11], 0
    v_mfma_f32_32x32x16_bf16 v[112:127], v[128:131], v[12:15], 0
    s_nop 15
    v_max3_f32 v162, v162, v96, v97
    v_max3_f32 v162, v162, v98, v99
    v_max3_f32 v162, v162, v100, v101
    v_max3_f32 v162, v162, v102, v103
    v_max3_f32 v162, v162, v104, v105
    v_max3_f32 v162, v162, v106, v107
    v_max3_f32 v162, v162, v108, v109
    v_max3_f32 v162, v162, v110, v111
    v_max3_f32 v163, v163, v112, v113
    v_max3_f32 v163, v163, v114, v115
    v_max3_f32 v163, v163, v116, v117
    v_max3_f32 v163, v163, v118, v119
    v_max3_f32 v163, v163, v120, v121
    v_max3_f32 v163, v163, v122, v123
    v_max3_f32 v163, v163, v124, v125
    v_max3_f32 v163, v163, v126, v127
    s_add_u32 s52, s52, 1
    s_cmp_lt_u32 s52, 64
    s_cbranch_scc1 p3a_max
    v_mov_b32 v5, v162
    s_nop 1
    v_permlane32_swap_b32 v5, v162
    s_nop 1
    v_max_f32 v162, v162, v5
    v_sub_f32 v32, 0, v162
    v_sub_f32 v33, 0, v162
    v_sub_f32 v34, 0, v162
    v_sub_f32 v35, 0, v162
    v_sub_f32 v36, 0, v162
    v_sub_f32 v37, 0, v162
    v_sub_f32 v38, 0, v162
    v_sub_f32 v39, 0, v162
    v_sub_f32 v40, 0, v162
    v_sub_f32 v41, 0, v162
    v_sub_f32 v42, 0, v162
    v_sub_f32 v43, 0, v162
    v_sub_f32 v44, 0, v162
    v_sub_f32 v45, 0, v162
    v_sub_f32 v46, 0, v162
    v_sub_f32 v47, 0, v162
    v_mov_b32 v5, v163
    s_nop 1
    v_permlane32_swap_b32 v5, v163
    s_nop 1
    v_max_f32 v163, v163, v5
    v_sub_f32 v48, 0, v163
    v_sub_f32 v49, 0, v163
    v_sub_f32 v50, 0, v163
    v_sub_f32 v51, 0, v163
    v_sub_f32 v52, 0, v163
    v_sub_f32 v53, 0, v163
    v_sub_f32 v54, 0, v163
    v_sub_f32 v55, 0, v163
    v_sub_f32 v56, 0, v163
    v_sub_f32 v57, 0, v163
    v_sub_f32 v58, 0, v163
    v_sub_f32 v59, 0, v163
    v_sub_f32 v60, 0, v163
    v_sub_f32 v61, 0, v163
    v_sub_f32 v62, 0, v163
    v_sub_f32 v63, 0, v163
    s_branch p3a_start
p3a_ok:
    v_rcp_f32 v6, v6
    v_rcp_f32 v161, v161
    s_lshr_b32 s28, s48, 5
    s_mul_i32 s28, s28, 294912
    s_lshl_b32 s29, s67, 11
    s_add_u32 s28, s28, s29
    s_add_u32 s28, s28, 34865152
    v_mul_f32 v6, v6, v160
    v_mul_f32 v161, v161, v160
    v_mul_f32 v64, v6, v64
    v_mul_f32 v65, v6, v65
    v_mul_f32 v66, v6, v66
    v_mul_f32 v67, v6, v67
    v_mul_f32 v68, v6, v68
    v_mul_f32 v69, v6, v69
    v_mul_f32 v70, v6, v70
    v_mul_f32 v71, v6, v71
    v_cvt_pk_bf16_f32 v16, v64, v65
    v_cvt_pk_bf16_f32 v17, v66, v67
    v_cvt_pk_bf16_f32 v18, v68, v69
    v_cvt_pk_bf16_f32 v19, v70, v71
    buffer_store_dwordx4 v[16:19], v1, s[20:23], s28 offen offset:0 sc1
    v_mul_f32 v80, v161, v80
    v_mul_f32 v81, v161, v81
    v_mul_f32 v82, v161, v82
    v_mul_f32 v83, v161, v83
    v_mul_f32 v84, v161, v84
    v_mul_f32 v85, v161, v85
    v_mul_f32 v86, v161, v86
    v_mul_f32 v87, v161, v87
    v_cvt_pk_bf16_f32 v24, v80, v81
    v_cvt_pk_bf16_f32 v25, v82, v83
    v_cvt_pk_bf16_f32 v26, v84, v85
    v_cvt_pk_bf16_f32 v27, v86, v87
    buffer_store_dwordx4 v[24:27], v1, s[20:23], s28 offen offset:1024 sc1
    s_waitcnt vmcnt(0)
    s_lshl_b32 s40, s66, 8
    s_add_u32 s40, s40, 57675776
    v_mov_b32 v2, 1
    v_mov_b32 v3, 0
    s_mov_b64 exec, 1
    buffer_atomic_add v2, v3, s[20:23], s40 offen sc1
    s_mov_b64 exec, -1
    s_endpgm
p3_g:
    s_setprio 0
    s_and_b32 s28, s2, 7
    s_lshl_b32 s28, s28, 1
    s_lshr_b32 s29, s2, 7
    s_add_u32 s66, s28, s29
    s_lshr_b32 s67, s2, 3
    s_and_b32 s67, s67, 15
    s_mov_b32 s16, s74
    s_mov_b32 s17, s75
    s_mov_b32 s18, 2097152
    s_mov_b32 s19, 0x00020000
    s_and_b32 s28, s2, 7
    s_lshl_b32 s28, s28, 2
    s_lshr_b32 s29, s2, 6
    s_add_u32 s6, s28, s29
    s_lshr_b32 s7, s2, 3
    s_and_b32 s7, s7, 7
    s_mul_i32 s44, s6, 589824
    s_lshl_b32 s28, s3, 11
    s_add_u32 s44, s44, s28
    s_add_u32 s44, s44, 34603008
    s_add_u32 s45, s44, 294912
    s_lshl_b32 s46, s3, 15
    s_lshl_b32 s28, s7, 11
    s_add_u32 s46, s46, s28
    s_add_u32 s46, s46, 67108864
    s_add_u32 s47, s46, 16384
    s_barrier
    s_cmp_lg_u32 s3, 0
    s_cbranch_scc1 p3g_ns
    s_lshl_b32 s40, s49, 8
    s_add_u32 s40, s40, 57671680
    v_mov_b32 v2, 1
    v_mov_b32 v3, 0
    s_mov_b64 exec, 1
    buffer_atomic_add v2, v3, s[20:23], s40 offen sc1
    s_mov_b64 exec, -1
    s_sub_u32 s49, 15, s49
    s_lshl_b32 s40, s49, 8
    s_add_u32 s40, s40, 57671680
    v_mov_b32 v2, 1
    v_mov_b32 v3, 0
    s_mov_b64 exec, 1
    buffer_atomic_add v2, v3, s[20:23], s40 offen sc1
    s_mov_b64 exec, -1
p3g_ns:
    s_mov_b32 s40, 57680128
    v_mov_b32 v3, 0
    s_mov_b32 s41, 0
poll_64:
    buffer_load_dword v2, v3, s[20:23], s40 offen sc1
    s_waitcnt vmcnt(0)
    v_readfirstlane_b32 s29, v2
    s_cmp_ge_u32 s29, 256
    s_cbranch_scc1 polled_65
    s_sleep 8
    s_add_u32 s41, s41, 1
    s_cmp_lt_u32 s41, 0x100000
    s_cbranch_scc1 poll_64
polled_65:
    v_mov_b32 v192, 0
    v_mov_b32 v193, 0
    v_mov_b32 v194, 0
    v_mov_b32 v195, 0
    v_mov_b32 v196, 0
    v_mov_b32 v197, 0
    v_mov_b32 v198, 0
    v_mov_b32 v199, 0
    v_mov_b32 v200, 0
    v_mov_b32 v201, 0
    v_mov_b32 v202, 0
    v_mov_b32 v203, 0
    v_mov_b32 v204, 0
    v_mov_b32 v205, 0
    v_mov_b32 v206, 0
    v_mov_b32 v207, 0
    v_mov_b32 v208, 0
    v_mov_b32 v209, 0
    v_mov_b32 v210, 0
    v_mov_b32 v211, 0
    v_mov_b32 v212, 0
    v_mov_b32 v213, 0
    v_mov_b32 v214, 0
    v_mov_b32 v215, 0
    v_mov_b32 v216, 0
    v_mov_b32 v217, 0
    v_mov_b32 v218, 0
    v_mov_b32 v219, 0
    v_mov_b32 v220, 0
    v_mov_b32 v221, 0
    v_mov_b32 v222, 0
    v_mov_b32 v223, 0
    v_mov_b32 v224, 0
    v_mov_b32 v225, 0
    v_mov_b32 v226, 0
    v_mov_b32 v227, 0
    v_mov_b32 v228, 0
    v_mov_b32 v229, 0
    v_mov_b32 v230, 0
    v_mov_b32 v231, 0
    v_mov_b32 v232, 0
    v_mov_b32 v233, 0
    v_mov_b32 v234, 0
    v_mov_b32 v235, 0
    v_mov_b32 v236, 0
    v_mov_b32 v237, 0
    v_mov_b32 v238, 0
    v_mov_b32 v239, 0
    v_mov_b32 v240, 0
    v_mov_b32 v241, 0
    v_mov_b32 v242, 0
    v_mov_b32 v243, 0
    v_mov_b32 v244, 0
    v_mov_b32 v245, 0
    v_mov_b32 v246, 0
    v_mov_b32 v247, 0
    v_mov_b32 v248, 0
    v_mov_b32 v249, 0
    v_mov_b32 v250, 0
    v_mov_b32 v251, 0
    v_mov_b32 v252, 0
    v_mov_b32 v253, 0
    v_mov_b32 v254, 0
    v_mov_b32 v255, 0
    s_lshl_b32 s40, s66, 8
    s_add_u32 s40, s40, 57671680
    v_mov_b32 v3, 0
    s_mov_b32 s41, 0
poll_66:
    buffer_load_dword v2, v3, s[20:23], s40 offen sc1
    s_waitcnt vmcnt(0)
    v_readfirstlane_b32 s29, v2
    s_cmp_ge_u32 s29, 32
    s_cbranch_scc1 polled_67
    s_sleep 8
    s_add_u32 s41, s41, 1
    s_cmp_lt_u32 s41, 0x100000
    s_cbranch_scc1 poll_66
polled_67:
    v_and_b32 v9, 31, v0
    s_lshl_b32 s28, s6, 6
    v_add_u32 v9, s28, v9
    v_lshlrev_b32 v4, 3, v9
    buffer_load_dwordx4 v[48:51], v1, s[20:23], s46 offen sc1
    buffer_load_dwordx4 v[52:55], v1, s[20:23], s46 offen offset:1024 sc1
    buffer_load_dwordx4 v[56:59], v1, s[20:23], s47 offen sc1
    buffer_load_dwordx4 v[60:63], v1, s[20:23], s47 offen offset:1024 sc1
    s_add_u32 s46, s46, 131072
    s_add_u32 s47, s47, 131072
    buffer_load_dwordx4 v[32:35], v1, s[20:23], s44 offen sc1
    buffer_load_dwordx4 v[36:39], v1, s[20:23], s44 offen offset:1024 sc1
    buffer_load_dwordx4 v[40:43], v1, s[20:23], s45 offen sc1
    buffer_load_dwordx4 v[44:47], v1, s[20:23], s45 offen offset:1024 sc1
    s_add_u32 s44, s44, 8192
    s_add_u32 s45, s45, 8192
    buffer_load_dwordx4 v[80:83], v1, s[20:23], s46 offen sc1
    buffer_load_dwordx4 v[84:87], v1, s[20:23], s46 offen offset:1024 sc1
    buffer_load_dwordx4 v[88:91], v1, s[20:23], s47 offen sc1
    buffer_load_dwordx4 v[92:95], v1, s[20:23], s47 offen offset:1024 sc1
    s_add_u32 s46, s46, 131072
    s_add_u32 s47, s47, 131072
    buffer_load_dwordx4 v[64:67], v1, s[20:23], s44 offen sc1
    buffer_load_dwordx4 v[68:71], v1, s[20:23], s44 offen offset:1024 sc1
    buffer_load_dwordx4 v[72:75], v1, s[20:23], s45 offen sc1
    buffer_load_dwordx4 v[76:79], v1, s[20:23], s45 offen offset:1024 sc1
    s_add_u32 s44, s44, 8192
    s_add_u32 s45, s45, 8192
    buffer_load_dwordx4 v[112:115], v1, s[20:23], s46 offen sc1
    buffer_load_dwordx4 v[116:119], v1, s[20:23], s46 offen offset:1024 sc1
    buffer_load_dwordx4 v[120:123], v1, s[20:23], s47 offen sc1
    buffer_load_dwordx4 v[124:127], v1, s[20:23], s47 offen offset:1024 sc1
    s_add_u32 s46, s46, 131072
    s_add_u32 s47, s47, 131072
    buffer_load_dwordx4 v[96:99], v1, s[20:23], s44 offen sc1
    buffer_load_dwordx4 v[100:103], v1, s[20:23], s44 offen offset:1024 sc1
    buffer_load_dwordx4 v[104:107], v1, s[20:23], s45 offen sc1
    buffer_load_dwordx4 v[108:111], v1, s[20:23], s45 offen offset:1024 sc1
    s_add_u32 s44, s44, 8192
    s_add_u32 s45, s45, 8192
    buffer_load_dwordx4 v[144:147], v1, s[20:23], s46 offen sc1
    buffer_load_dwordx4 v[148:151], v1, s[20:23], s46 offen offset:1024 sc1
    buffer_load_dwordx4 v[152:155], v1, s[20:23], s47 offen sc1
    buffer_load_dwordx4 v[156:159], v1, s[20:23], s47 offen offset:1024 sc1
    s_add_u32 s46, s46, 131072
    s_add_u32 s47, s47, 131072
    buffer_load_dwordx4 v[128:131], v1, s[20:23], s44 offen sc1
    buffer_load_dwordx4 v[132:135], v1, s[20:23], s44 offen offset:1024 sc1
    buffer_load_dwordx4 v[136:139], v1, s[20:23], s45 offen sc1
    buffer_load_dwordx4 v[140:143], v1, s[20:23], s45 offen offset:1024 sc1
    s_add_u32 s44, s44, 8192
    s_add_u32 s45, s45, 8192
    s_mov_b32 s48, 0
p3g_loop:
    s_waitcnt vmcnt(24)
    v_mfma_f32_32x32x16_bf16 v[192:207], v[48:51], v[32:35], v[192:207]
    v_mfma_f32_32x32x16_bf16 v[208:223], v[48:51], v[40:43], v[208:223]
    v_mfma_f32_32x32x16_bf16 v[224:239], v[52:55], v[32:35], v[224:239]
    v_mfma_f32_32x32x16_bf16 v[240:255], v[52:55], v[40:43], v[240:255]
    v_mfma_f32_32x32x16_bf16 v[192:207], v[56:59], v[36:39], v[192:207]
    v_mfma_f32_32x32x16_bf16 v[208:223], v[56:59], v[44:47], v[208:223]
    v_mfma_f32_32x32x16_bf16 v[224:239], v[60:63], v[36:39], v[224:239]
    v_mfma_f32_32x32x16_bf16 v[240:255], v[60:63], v[44:47], v[240:255]
    buffer_load_dwordx4 v[48:51], v1, s[20:23], s46 offen sc1
    buffer_load_dwordx4 v[52:55], v1, s[20:23], s46 offen offset:1024 sc1
    buffer_load_dwordx4 v[56:59], v1, s[20:23], s47 offen sc1
    buffer_load_dwordx4 v[60:63], v1, s[20:23], s47 offen offset:1024 sc1
    s_add_u32 s46, s46, 131072
    s_add_u32 s47, s47, 131072
    buffer_load_dwordx4 v[32:35], v1, s[20:23], s44 offen sc1
    buffer_load_dwordx4 v[36:39], v1, s[20:23], s44 offen offset:1024 sc1
    buffer_load_dwordx4 v[40:43], v1, s[20:23], s45 offen sc1
    buffer_load_dwordx4 v[44:47], v1, s[20:23], s45 offen offset:1024 sc1
    s_add_u32 s44, s44, 8192
    s_add_u32 s45, s45, 8192
    s_waitcnt vmcnt(24)
    v_mfma_f32_32x32x16_bf16 v[192:207], v[80:83], v[64:67], v[192:207]
    v_mfma_f32_32x32x16_bf16 v[208:223], v[80:83], v[72:75], v[208:223]
    v_mfma_f32_32x32x16_bf16 v[224:239], v[84:87], v[64:67], v[224:239]
    v_mfma_f32_32x32x16_bf16 v[240:255], v[84:87], v[72:75], v[240:255]
    v_mfma_f32_32x32x16_bf16 v[192:207], v[88:91], v[68:71], v[192:207]
    v_mfma_f32_32x32x16_bf16 v[208:223], v[88:91], v[76:79], v[208:223]
    v_mfma_f32_32x32x16_bf16 v[224:239], v[92:95], v[68:71], v[224:239]
    v_mfma_f32_32x32x16_bf16 v[240:255], v[92:95], v[76:79], v[240:255]
    buffer_load_dwordx4 v[80:83], v1, s[20:23], s46 offen sc1
    buffer_load_dwordx4 v[84:87], v1, s[20:23], s46 offen offset:1024 sc1
    buffer_load_dwordx4 v[88:91], v1, s[20:23], s47 offen sc1
    buffer_load_dwordx4 v[92:95], v1, s[20:23], s47 offen offset:1024 sc1
    s_add_u32 s46, s46, 131072
    s_add_u32 s47, s47, 131072
    buffer_load_dwordx4 v[64:67], v1, s[20:23], s44 offen sc1
    buffer_load_dwordx4 v[68:71], v1, s[20:23], s44 offen offset:1024 sc1
    buffer_load_dwordx4 v[72:75], v1, s[20:23], s45 offen sc1
    buffer_load_dwordx4 v[76:79], v1, s[20:23], s45 offen offset:1024 sc1
    s_add_u32 s44, s44, 8192
    s_add_u32 s45, s45, 8192
    s_waitcnt vmcnt(24)
    v_mfma_f32_32x32x16_bf16 v[192:207], v[112:115], v[96:99], v[192:207]
    v_mfma_f32_32x32x16_bf16 v[208:223], v[112:115], v[104:107], v[208:223]
    v_mfma_f32_32x32x16_bf16 v[224:239], v[116:119], v[96:99], v[224:239]
    v_mfma_f32_32x32x16_bf16 v[240:255], v[116:119], v[104:107], v[240:255]
    v_mfma_f32_32x32x16_bf16 v[192:207], v[120:123], v[100:103], v[192:207]
    v_mfma_f32_32x32x16_bf16 v[208:223], v[120:123], v[108:111], v[208:223]
    v_mfma_f32_32x32x16_bf16 v[224:239], v[124:127], v[100:103], v[224:239]
    v_mfma_f32_32x32x16_bf16 v[240:255], v[124:127], v[108:111], v[240:255]
    buffer_load_dwordx4 v[112:115], v1, s[20:23], s46 offen sc1
    buffer_load_dwordx4 v[116:119], v1, s[20:23], s46 offen offset:1024 sc1
    buffer_load_dwordx4 v[120:123], v1, s[20:23], s47 offen sc1
    buffer_load_dwordx4 v[124:127], v1, s[20:23], s47 offen offset:1024 sc1
    s_add_u32 s46, s46, 131072
    s_add_u32 s47, s47, 131072
    buffer_load_dwordx4 v[96:99], v1, s[20:23], s44 offen sc1
    buffer_load_dwordx4 v[100:103], v1, s[20:23], s44 offen offset:1024 sc1
    buffer_load_dwordx4 v[104:107], v1, s[20:23], s45 offen sc1
    buffer_load_dwordx4 v[108:111], v1, s[20:23], s45 offen offset:1024 sc1
    s_add_u32 s44, s44, 8192
    s_add_u32 s45, s45, 8192
    s_waitcnt vmcnt(24)
    v_mfma_f32_32x32x16_bf16 v[192:207], v[144:147], v[128:131], v[192:207]
    v_mfma_f32_32x32x16_bf16 v[208:223], v[144:147], v[136:139], v[208:223]
    v_mfma_f32_32x32x16_bf16 v[224:239], v[148:151], v[128:131], v[224:239]
    v_mfma_f32_32x32x16_bf16 v[240:255], v[148:151], v[136:139], v[240:255]
    v_mfma_f32_32x32x16_bf16 v[192:207], v[152:155], v[132:135], v[192:207]
    v_mfma_f32_32x32x16_bf16 v[208:223], v[152:155], v[140:143], v[208:223]
    v_mfma_f32_32x32x16_bf16 v[224:239], v[156:159], v[132:135], v[224:239]
    v_mfma_f32_32x32x16_bf16 v[240:255], v[156:159], v[140:143], v[240:255]
    buffer_load_dwordx4 v[144:147], v1, s[20:23], s46 offen sc1
    buffer_load_dwordx4 v[148:151], v1, s[20:23], s46 offen offset:1024 sc1
    buffer_load_dwordx4 v[152:155], v1, s[20:23], s47 offen sc1
    buffer_load_dwordx4 v[156:159], v1, s[20:23], s47 offen offset:1024 sc1
    s_add_u32 s46, s46, 131072
    s_add_u32 s47, s47, 131072
    buffer_load_dwordx4 v[128:131], v1, s[20:23], s44 offen sc1
    buffer_load_dwordx4 v[132:135], v1, s[20:23], s44 offen offset:1024 sc1
    buffer_load_dwordx4 v[136:139], v1, s[20:23], s45 offen sc1
    buffer_load_dwordx4 v[140:143], v1, s[20:23], s45 offen offset:1024 sc1
    s_add_u32 s44, s44, 8192
    s_add_u32 s45, s45, 8192
    s_add_u32 s48, s48, 1
    s_cmp_lt_u32 s48, 7
    s_cbranch_scc1 p3g_loop
    s_waitcnt vmcnt(24)
    v_mfma_f32_32x32x16_bf16 v[192:207], v[48:51], v[32:35], v[192:207]
    v_mfma_f32_32x32x16_bf16 v[208:223], v[48:51], v[40:43], v[208:223]
    v_mfma_f32_32x32x16_bf16 v[224:239], v[52:55], v[32:35], v[224:239]
    v_mfma_f32_32x32x16_bf16 v[240:255], v[52:55], v[40:43], v[240:255]
    v_mfma_f32_32x32x16_bf16 v[192:207], v[56:59], v[36:39], v[192:207]
    v_mfma_f32_32x32x16_bf16 v[208:223], v[56:59], v[44:47], v[208:223]
    v_mfma_f32_32x32x16_bf16 v[224:239], v[60:63], v[36:39], v[224:239]
    v_mfma_f32_32x32x16_bf16 v[240:255], v[60:63], v[44:47], v[240:255]
    buffer_load_dwordx4 v[48:51], v1, s[20:23], s46 offen sc1
    buffer_load_dwordx4 v[52:55], v1, s[20:23], s46 offen offset:1024 sc1
    buffer_load_dwordx4 v[56:59], v1, s[20:23], s47 offen sc1
    buffer_load_dwordx4 v[60:63], v1, s[20:23], s47 offen offset:1024 sc1
    s_add_u32 s46, s46, 131072
    s_add_u32 s47, s47, 131072
    s_waitcnt vmcnt(20)
    v_mfma_f32_32x32x16_bf16 v[192:207], v[80:83], v[64:67], v[192:207]
    v_mfma_f32_32x32x16_bf16 v[208:223], v[80:83], v[72:75], v[208:223]
    v_mfma_f32_32x32x16_bf16 v[224:239], v[84:87], v[64:67], v[224:239]
    v_mfma_f32_32x32x16_bf16 v[240:255], v[84:87], v[72:75], v[240:255]
    v_mfma_f32_32x32x16_bf16 v[192:207], v[88:91], v[68:71], v[192:207]
    v_mfma_f32_32x32x16_bf16 v[208:223], v[88:91], v[76:79], v[208:223]
    v_mfma_f32_32x32x16_bf16 v[224:239], v[92:95], v[68:71], v[224:239]
    v_mfma_f32_32x32x16_bf16 v[240:255], v[92:95], v[76:79], v[240:255]
    buffer_load_dwordx4 v[80:83], v1, s[20:23], s46 offen sc1
    buffer_load_dwordx4 v[84:87], v1, s[20:23], s46 offen offset:1024 sc1
    buffer_load_dwordx4 v[88:91], v1, s[20:23], s47 offen sc1
    buffer_load_dwordx4 v[92:95], v1, s[20:23], s47 offen offset:1024 sc1
    s_add_u32 s46, s46, 131072
    s_add_u32 s47, s47, 131072
    s_waitcnt vmcnt(16)
    v_mfma_f32_32x32x16_bf16 v[192:207], v[112:115], v[96:99], v[192:207]
    v_mfma_f32_32x32x16_bf16 v[208:223], v[112:115], v[104:107], v[208:223]
    v_mfma_f32_32x32x16_bf16 v[224:239], v[116:119], v[96:99], v[224:239]
    v_mfma_f32_32x32x16_bf16 v[240:255], v[116:119], v[104:107], v[240:255]
    v_mfma_f32_32x32x16_bf16 v[192:207], v[120:123], v[100:103], v[192:207]
    v_mfma_f32_32x32x16_bf16 v[208:223], v[120:123], v[108:111], v[208:223]
    v_mfma_f32_32x32x16_bf16 v[224:239], v[124:127], v[100:103], v[224:239]
    v_mfma_f32_32x32x16_bf16 v[240:255], v[124:127], v[108:111], v[240:255]
    buffer_load_dwordx4 v[112:115], v1, s[20:23], s46 offen sc1
    buffer_load_dwordx4 v[116:119], v1, s[20:23], s46 offen offset:1024 sc1
    buffer_load_dwordx4 v[120:123], v1, s[20:23], s47 offen sc1
    buffer_load_dwordx4 v[124:127], v1, s[20:23], s47 offen offset:1024 sc1
    s_add_u32 s46, s46, 131072
    s_add_u32 s47, s47, 131072
    s_waitcnt vmcnt(12)
    v_mfma_f32_32x32x16_bf16 v[192:207], v[144:147], v[128:131], v[192:207]
    v_mfma_f32_32x32x16_bf16 v[208:223], v[144:147], v[136:139], v[208:223]
    v_mfma_f32_32x32x16_bf16 v[224:239], v[148:151], v[128:131], v[224:239]
    v_mfma_f32_32x32x16_bf16 v[240:255], v[148:151], v[136:139], v[240:255]
    v_mfma_f32_32x32x16_bf16 v[192:207], v[152:155], v[132:135], v[192:207]
    v_mfma_f32_32x32x16_bf16 v[208:223], v[152:155], v[140:143], v[208:223]
    v_mfma_f32_32x32x16_bf16 v[224:239], v[156:159], v[132:135], v[224:239]
    v_mfma_f32_32x32x16_bf16 v[240:255], v[156:159], v[140:143], v[240:255]
    buffer_load_dwordx4 v[144:147], v1, s[20:23], s46 offen sc1
    buffer_load_dwordx4 v[148:151], v1, s[20:23], s46 offen offset:1024 sc1
    buffer_load_dwordx4 v[152:155], v1, s[20:23], s47 offen sc1
    buffer_load_dwordx4 v[156:159], v1, s[20:23], s47 offen offset:1024 sc1
    s_add_u32 s46, s46, 131072
    s_add_u32 s47, s47, 131072
    s_mov_b32 s40, 57679872
    v_mov_b32 v3, 0
    s_mov_b32 s41, 0
poll_68:
    buffer_load_dword v2, v3, s[20:23], s40 offen sc1
    s_waitcnt vmcnt(0)
    v_readfirstlane_b32 s29, v2
    s_cmp_ge_u32 s29, 64
    s_cbranch_scc1 polled_69
    s_sleep 8
    s_add_u32 s41, s41, 1
    s_cmp_lt_u32 s41, 0x100000
    s_cbranch_scc1 poll_68
polled_69:
    s_mov_b32 s28, 33816576
    buffer_load_dword v10, v4, s[20:23], s28 offen offset:4 sc1
    buffer_load_dword v11, v4, s[20:23], s28 offen offset:260 sc1
    s_waitcnt vmcnt(0)
    v_mul_f32 v192, v10, v192
    v_mul_f32 v193, v10, v193
    v_mul_f32 v194, v10, v194
    v_mul_f32 v195, v10, v195
    v_mul_f32 v196, v10, v196
    v_mul_f32 v197, v10, v197
    v_mul_f32 v198, v10, v198
    v_mul_f32 v199, v10, v199
    v_mul_f32 v200, v10, v200
    v_mul_f32 v201, v10, v201
    v_mul_f32 v202, v10, v202
    v_mul_f32 v203, v10, v203
    v_mul_f32 v204, v10, v204
    v_mul_f32 v205, v10, v205
    v_mul_f32 v206, v10, v206
    v_mul_f32 v207, v10, v207
    v_mul_f32 v208, v11, v208
    v_mul_f32 v209, v11, v209
    v_mul_f32 v210, v11, v210
    v_mul_f32 v211, v11, v211
    v_mul_f32 v212, v11, v212
    v_mul_f32 v213, v11, v213
    v_mul_f32 v214, v11, v214
    v_mul_f32 v215, v11, v215
    v_mul_f32 v216, v11, v216
    v_mul_f32 v217, v11, v217
    v_mul_f32 v218, v11, v218
    v_mul_f32 v219, v11, v219
    v_mul_f32 v220, v11, v220
    v_mul_f32 v221, v11, v221
    v_mul_f32 v222, v11, v222
    v_mul_f32 v223, v11, v223
    v_mul_f32 v224, v10, v224
    v_mul_f32 v225, v10, v225
    v_mul_f32 v226, v10, v226
    v_mul_f32 v227, v10, v227
    v_mul_f32 v228, v10, v228
    v_mul_f32 v229, v10, v229
    v_mul_f32 v230, v10, v230
    v_mul_f32 v231, v10, v231
    v_mul_f32 v232, v10, v232
    v_mul_f32 v233, v10, v233
    v_mul_f32 v234, v10, v234
    v_mul_f32 v235, v10, v235
    v_mul_f32 v236, v10, v236
    v_mul_f32 v237, v10, v237
    v_mul_f32 v238, v10, v238
    v_mul_f32 v239, v10, v239
    v_mul_f32 v240, v11, v240
    v_mul_f32 v241, v11, v241
    v_mul_f32 v242, v11, v242
    v_mul_f32 v243, v11, v243
    v_mul_f32 v244, v11, v244
    v_mul_f32 v245, v11, v245
    v_mul_f32 v246, v11, v246
    v_mul_f32 v247, v11, v247
    v_mul_f32 v248, v11, v248
    v_mul_f32 v249, v11, v249
    v_mul_f32 v250, v11, v250
    v_mul_f32 v251, v11, v251
    v_mul_f32 v252, v11, v252
    v_mul_f32 v253, v11, v253
    v_mul_f32 v254, v11, v254
    v_mul_f32 v255, v11, v255
    s_lshl_b32 s40, s66, 8
    s_add_u32 s40, s40, 57675776
    v_mov_b32 v3, 0
    s_mov_b32 s41, 0
poll_70:
    buffer_load_dword v2, v3, s[20:23], s40 offen sc1
    s_waitcnt vmcnt(0)
    v_readfirstlane_b32 s29, v2
    s_cmp_ge_u32 s29, 64
    s_cbranch_scc1 polled_71
    s_sleep 4
    s_add_u32 s41, s41, 1
    s_cmp_lt_u32 s41, 0x100000
    s_cbranch_scc1 poll_70
polled_71:
    buffer_load_dwordx4 v[32:35], v1, s[20:23], s44 offen sc1
    buffer_load_dwordx4 v[36:39], v1, s[20:23], s44 offen offset:1024 sc1
    buffer_load_dwordx4 v[40:43], v1, s[20:23], s45 offen sc1
    buffer_load_dwordx4 v[44:47], v1, s[20:23], s45 offen offset:1024 sc1
    s_add_u32 s44, s44, 8192
    s_add_u32 s45, s45, 8192
    buffer_load_dwordx4 v[64:67], v1, s[20:23], s44 offen sc1
    buffer_load_dwordx4 v[68:71], v1, s[20:23], s44 offen offset:1024 sc1
    buffer_load_dwordx4 v[72:75], v1, s[20:23], s45 offen sc1
    buffer_load_dwordx4 v[76:79], v1, s[20:23], s45 offen offset:1024 sc1
    s_add_u32 s44, s44, 8192
    s_add_u32 s45, s45, 8192
    buffer_load_dwordx4 v[96:99], v1, s[20:23], s44 offen sc1
    buffer_load_dwordx4 v[100:103], v1, s[20:23], s44 offen offset:1024 sc1
    buffer_load_dwordx4 v[104:107], v1, s[20:23], s45 offen sc1
    buffer_load_dwordx4 v[108:111], v1, s[20:23], s45 offen offset:1024 sc1
    s_add_u32 s44, s44, 8192
    s_add_u32 s45, s45, 8192
    buffer_load_dwordx4 v[128:131], v1, s[20:23], s44 offen sc1
    buffer_load_dwordx4 v[132:135], v1, s[20:23], s44 offen offset:1024 sc1
    buffer_load_dwordx4 v[136:139], v1, s[20:23], s45 offen sc1
    buffer_load_dwordx4 v[140:143], v1, s[20:23], s45 offen offset:1024 sc1
    s_add_u32 s44, s44, 8192
    s_add_u32 s45, s45, 8192
    s_waitcnt vmcnt(12)
    v_mfma_f32_32x32x16_bf16 v[192:207], v[48:51], v[32:35], v[192:207]
    v_mfma_f32_32x32x16_bf16 v[208:223], v[48:51], v[40:43], v[208:223]
    v_mfma_f32_32x32x16_bf16 v[224:239], v[52:55], v[32:35], v[224:239]
    v_mfma_f32_32x32x16_bf16 v[240:255], v[52:55], v[40:43], v[240:255]
    v_mfma_f32_32x32x16_bf16 v[192:207], v[56:59], v[36:39], v[192:207]
    v_mfma_f32_32x32x16_bf16 v[208:223], v[56:59], v[44:47], v[208:223]
    v_mfma_f32_32x32x16_bf16 v[224:239], v[60:63], v[36:39], v[224:239]
    v_mfma_f32_32x32x16_bf16 v[240:255], v[60:63], v[44:47], v[240:255]
    s_waitcnt vmcnt(8)
    v_mfma_f32_32x32x16_bf16 v[192:207], v[80:83], v[64:67], v[192:207]
    v_mfma_f32_32x32x16_bf16 v[208:223], v[80:83], v[72:75], v[208:223]
    v_mfma_f32_32x32x16_bf16 v[224:239], v[84:87], v[64:67], v[224:239]
    v_mfma_f32_32x32x16_bf16 v[240:255], v[84:87], v[72:75], v[240:255]
    v_mfma_f32_32x32x16_bf16 v[192:207], v[88:91], v[68:71], v[192:207]
    v_mfma_f32_32x32x16_bf16 v[208:223], v[88:91], v[76:79], v[208:223]
    v_mfma_f32_32x32x16_bf16 v[224:239], v[92:95], v[68:71], v[224:239]
    v_mfma_f32_32x32x16_bf16 v[240:255], v[92:95], v[76:79], v[240:255]
    s_waitcnt vmcnt(4)
    v_mfma_f32_32x32x16_bf16 v[192:207], v[112:115], v[96:99], v[192:207]
    v_mfma_f32_32x32x16_bf16 v[208:223], v[112:115], v[104:107], v[208:223]
    v_mfma_f32_32x32x16_bf16 v[224:239], v[116:119], v[96:99], v[224:239]
    v_mfma_f32_32x32x16_bf16 v[240:255], v[116:119], v[104:107], v[240:255]
    v_mfma_f32_32x32x16_bf16 v[192:207], v[120:123], v[100:103], v[192:207]
    v_mfma_f32_32x32x16_bf16 v[208:223], v[120:123], v[108:111], v[208:223]
    v_mfma_f32_32x32x16_bf16 v[224:239], v[124:127], v[100:103], v[224:239]
    v_mfma_f32_32x32x16_bf16 v[240:255], v[124:127], v[108:111], v[240:255]
    s_waitcnt vmcnt(0)
    v_mfma_f32_32x32x16_bf16 v[192:207], v[144:147], v[128:131], v[192:207]
    v_mfma_f32_32x32x16_bf16 v[208:223], v[144:147], v[136:139], v[208:223]
    v_mfma_f32_32x32x16_bf16 v[224:239], v[148:151], v[128:131], v[224:239]
    v_mfma_f32_32x32x16_bf16 v[240:255], v[148:151], v[136:139], v[240:255]
    v_mfma_f32_32x32x16_bf16 v[192:207], v[152:155], v[132:135], v[192:207]
    v_mfma_f32_32x32x16_bf16 v[208:223], v[152:155], v[140:143], v[208:223]
    v_mfma_f32_32x32x16_bf16 v[224:239], v[156:159], v[132:135], v[224:239]
    v_mfma_f32_32x32x16_bf16 v[240:255], v[156:159], v[140:143], v[240:255]
    s_lshl_b32 s28, s3, 14
    v_add_u32 v7, s28, v1
    s_nop 15
    s_barrier
    ds_write_b128 v7, v[192:195] offset:0
    ds_write_b128 v7, v[196:199] offset:1024
    ds_write_b128 v7, v[200:203] offset:2048
    ds_write_b128 v7, v[204:207] offset:3072
    ds_write_b128 v7, v[208:211] offset:4096
    ds_write_b128 v7, v[212:215] offset:5120
    ds_write_b128 v7, v[216:219] offset:6144
    ds_write_b128 v7, v[220:223] offset:7168
    ds_write_b128 v7, v[224:227] offset:8192
    ds_write_b128 v7, v[228:231] offset:9216
    ds_write_b128 v7, v[232:235] offset:10240
    ds_write_b128 v7, v[236:239] offset:11264
    ds_write_b128 v7, v[240:243] offset:12288
    ds_write_b128 v7, v[244:247] offset:13312
    ds_write_b128 v7, v[248:251] offset:14336
    ds_write_b128 v7, v[252:255] offset:15360
    s_waitcnt lgkmcnt(0)
    s_barrier
    s_lshl_b32 s28, s3, 12
    v_add_u32 v7, s28, v1
    ds_read_b128 v[32:35], v7 offset:0
    ds_read_b128 v[36:39], v7 offset:16384
    ds_read_b128 v[40:43], v7 offset:32768
    ds_read_b128 v[44:47], v7 offset:49152
    ds_read_b128 v[48:51], v7 offset:1024
    ds_read_b128 v[52:55], v7 offset:17408
    ds_read_b128 v[56:59], v7 offset:33792
    ds_read_b128 v[60:63], v7 offset:50176
    ds_read_b128 v[64:67], v7 offset:2048
    ds_read_b128 v[68:71], v7 offset:18432
    ds_read_b128 v[72:75], v7 offset:34816
    ds_read_b128 v[76:79], v7 offset:51200
    ds_read_b128 v[80:83], v7 offset:3072
    ds_read_b128 v[84:87], v7 offset:19456
    ds_read_b128 v[88:91], v7 offset:35840
    ds_read_b128 v[92:95], v7 offset:52224
    s_and_b32 s28, s3, 1
    s_lshl_b32 s28, s28, 5
    v_add_u32 v9, s28, v9
    v_lshlrev_b32 v9, 10, v9
    v_lshrrev_b32 v10, 5, v0
    v_lshl_add_u32 v9, v10, 3, v9
    s_lshl_b32 s28, s7, 7
    s_lshr_b32 s29, s3, 1
    s_lshl_b32 s29, s29, 6
    s_add_u32 s28, s28, s29
    s_waitcnt lgkmcnt(12)
    v_add_f32 v32, v32, v36
    v_add_f32 v33, v33, v37
    v_add_f32 v34, v34, v38
    v_add_f32 v35, v35, v39
    v_add_f32 v32, v32, v40
    v_add_f32 v33, v33, v41
    v_add_f32 v34, v34, v42
    v_add_f32 v35, v35, v43
    v_add_f32 v32, v32, v44
    v_add_f32 v33, v33, v45
    v_add_f32 v34, v34, v46
    v_add_f32 v35, v35, v47
    v_cvt_pk_bf16_f32 v12, v32, v33
    v_cvt_pk_bf16_f32 v13, v34, v35
    buffer_store_dwordx2 v[12:13], v9, s[16:19], s28 offen offset:0
    s_waitcnt lgkmcnt(8)
    v_add_f32 v48, v48, v52
    v_add_f32 v49, v49, v53
    v_add_f32 v50, v50, v54
    v_add_f32 v51, v51, v55
    v_add_f32 v48, v48, v56
    v_add_f32 v49, v49, v57
    v_add_f32 v50, v50, v58
    v_add_f32 v51, v51, v59
    v_add_f32 v48, v48, v60
    v_add_f32 v49, v49, v61
    v_add_f32 v50, v50, v62
    v_add_f32 v51, v51, v63
    v_cvt_pk_bf16_f32 v14, v48, v49
    v_cvt_pk_bf16_f32 v15, v50, v51
    buffer_store_dwordx2 v[14:15], v9, s[16:19], s28 offen offset:16
    s_waitcnt lgkmcnt(4)
    v_add_f32 v64, v64, v68
    v_add_f32 v65, v65, v69
    v_add_f32 v66, v66, v70
    v_add_f32 v67, v67, v71
    v_add_f32 v64, v64, v72
    v_add_f32 v65, v65, v73
    v_add_f32 v66, v66, v74
    v_add_f32 v67, v67, v75
    v_add_f32 v64, v64, v76
    v_add_f32 v65, v65, v77
    v_add_f32 v66, v66, v78
    v_add_f32 v67, v67, v79
    v_cvt_pk_bf16_f32 v16, v64, v65
    v_cvt_pk_bf16_f32 v17, v66, v67
    buffer_store_dwordx2 v[16:17], v9, s[16:19], s28 offen offset:32
    s_waitcnt lgkmcnt(0)
    v_add_f32 v80, v80, v84
    v_add_f32 v81, v81, v85
    v_add_f32 v82, v82, v86
    v_add_f32 v83, v83, v87
    v_add_f32 v80, v80, v88
    v_add_f32 v81, v81, v89
    v_add_f32 v82, v82, v90
    v_add_f32 v83, v83, v91
    v_add_f32 v80, v80, v92
    v_add_f32 v81, v81, v93
    v_add_f32 v82, v82, v94
    v_add_f32 v83, v83, v95
    v_cvt_pk_bf16_f32 v18, v80, v81
    v_cvt_pk_bf16_f32 v19, v82, v83
    buffer_store_dwordx2 v[18:19], v9, s[16:19], s28 offen offset:48
k1_end:
    s_endpgm
code_end:
.section .rodata,"a"
.p2align 6
.amdhsa_kernel gated_mix__grouped_kv_mqa__compressed_kv_cla__prompt_kernel
  .amdhsa_next_free_vgpr 256
  .amdhsa_next_free_sgpr 102
  .amdhsa_accum_offset 256
  .amdhsa_group_segment_fixed_size 0
  .amdhsa_kernarg_size 120
  .amdhsa_user_sgpr_count 2
  .amdhsa_user_sgpr_kernarg_segment_ptr 1
  .amdhsa_system_sgpr_workgroup_id_x 1
.end_amdhsa_kernel
```
